```python
import torch

def _softmax(x, axis=-1):
    return torch.softmax(x, dim=axis)
def _gelu(x):
    return torch.nn.functional.gelu(x, approximate="tanh")
def _silu(x):
    return torch.nn.functional.silu(x)
def _sigmoid(x):
    return torch.sigmoid(x)
def _layernorm(x, axis=-1, eps=1e-5):
    m = x.mean(dim=axis, keepdim=True)
    v = x.var(dim=axis, keepdim=True, unbiased=False)
    return (x - m) / torch.sqrt(v + eps)
def _scatter_add(tgt, idx, src, axis=0):
    return tgt.clone().index_add_(axis, idx, src)
def _segment_sum(src, seg, n):
    out = torch.zeros((n,) + src.shape[1:], dtype=src.dtype)
    return out.index_add_(0, seg, src)
def _pad(x, pw):
    flat = tuple(v for pair in reversed(pw) for v in pair)
    return torch.nn.functional.pad(x, flat)

kernel_name = 'interleave_layers__gqa_block_cached__glu_gated_bilinear__decode'

def setup_inputs():

    _w = (lambda a: (lambda t: t.to(torch.bfloat16) if t.is_floating_point() else t)(torch.as_tensor(a)))
    def _A_setup():
        B, Sq, D = 2, 1, 512
        Hq, Hkv, Sk, Dh = 32, 32, 16384, 128
        assert Hq % Hkv == 0, (Hq, Hkv)
        return {
            "x": _w((lambda *s: torch.randn(*s, dtype=torch.bfloat16) * 0.05)(B, Sq, D)),
            "k_cache": _w((lambda *s: torch.randn(*s, dtype=torch.bfloat16) * 0.8)(B, Hkv, Sk, Dh)),
            "v_cache": _w((lambda *s: torch.randn(*s, dtype=torch.bfloat16) * 1.6)(B, Hkv, Sk, Dh)),
            "wq": _w((lambda *s: torch.randn(*s, dtype=torch.bfloat16) * 0.8)(D, Hq * Dh) * (D ** -0.5)),
            "wo": _w((lambda *s: torch.randn(*s, dtype=torch.bfloat16) * 1.6)(Hq * Dh, D) * ((Hq * Dh) ** -0.5)),
        }
    _A_in = _A_setup()

    def _B_setup():
        B, S, D, F = 2, 1, 512, 1376
        return {
            "x": _w((lambda *s: torch.randn(*s, dtype=torch.bfloat16) * 0.05)(B, S, D)),
            "w_gate": _w((lambda *s: torch.randn(*s, dtype=torch.bfloat16) * 0.4)(D, F) * (D ** -0.5)),
            "w_up": _w((lambda *s: torch.randn(*s, dtype=torch.bfloat16) * 0.4)(D, F) * (D ** -0.5)),
            "w_down": _w((lambda *s: torch.randn(*s, dtype=torch.bfloat16) * 0.4)(F, D) * (F ** -0.5)),
        }
    _B_in = _B_setup()

    return {
        "A_x": _A_in["x"],
        "A_k_cache": _A_in["k_cache"],
        "A_v_cache": _A_in["v_cache"],
        "A_wq": _A_in["wq"],
        "A_wo": _A_in["wo"],
        "B_x": _B_in["x"],
        "B_w_gate": _B_in["w_gate"],
        "B_w_up": _B_in["w_up"],
        "B_w_down": _B_in["w_down"],
    }

def reference(A_x, A_k_cache, A_v_cache, A_wq, A_wo, B_x, B_w_gate, B_w_up, B_w_down):
    def _A_ref(x, k_cache, v_cache, wq, wo):
        B, Sq, D = x.shape
        Hq, Dh = 32, 128
        Hkv = k_cache.shape[1]
        rep = Hq // Hkv
        q = (lambda x, *d: x.permute(*d))((x @ wq).reshape(B, Sq, Hq, Dh), 0, 2, 1, 3)
        k = (lambda x, n, axis: torch.repeat_interleave(x, n, dim=axis))(k_cache, rep, axis=1)
        v = (lambda x, n, axis: torch.repeat_interleave(x, n, dim=axis))(v_cache, rep, axis=1)
        scores = torch.einsum("bhqd,bhkd->bhqk", q, k) * (Dh ** -0.5)
        p = _softmax(scores, axis=-1)
        o = torch.einsum("bhqk,bhkd->bhqd", p, v)
        return (lambda x, *d: x.permute(*d))(o, 0, 2, 1, 3).reshape(B, Sq, Hq * Dh) @ wo

    def _B_ref(x, w_gate, w_up, w_down):
        g = torch.einsum("bsd,df->bsf", x, w_gate)
        u = torch.einsum("bsd,df->bsf", x, w_up)
        h = g * u
        return torch.einsum("bsf,fd->bsd", h, w_down)

    x = A_x
    x = x + _A_ref(_layernorm(x, axis=-1), A_k_cache, A_v_cache, A_wq, A_wo)
    x = x + _B_ref(_layernorm(x, axis=-1), B_w_gate, B_w_up, B_w_down)
    x = x + _A_ref(_layernorm(x, axis=-1), A_k_cache, A_v_cache, A_wq, A_wo)
    x = x + _B_ref(_layernorm(x, axis=-1), B_w_gate, B_w_up, B_w_down)
    return x
```

```asm
; @launch grid=(256,1,1) block=(256,1,1) lds=163840
.amdgcn_target "amdgcn-amd-amdhsa--gfx950"
.text
.globl interleave_layers__gqa_block_cached__glu_gated_bilinear__decode_kernel
.p2align 8
.type interleave_layers__gqa_block_cached__glu_gated_bilinear__decode_kernel,@function
interleave_layers__gqa_block_cached__glu_gated_bilinear__decode_kernel:
  s_cmp_ge_u32 s2, 256
  s_cbranch_scc1 L_end
  s_load_dwordx16 s[4:19], s[0:1], 0
  s_load_dwordx8 s[20:27], s[0:1], 64
  v_lshrrev_b32 v1, 6, v0
  v_and_b32 v0, 63, v0
  v_readfirstlane_b32 s3, v1
  s_mov_b32 s99, 0
  s_mov_b32 s93, 0
  s_cmp_lt_u32 s2, 32
  s_cbranch_scc1 L_chain
L_stream:
  s_sub_u32 s67, s2, 32
  s_and_b32 s68, s67, 7
  s_lshr_b32 s67, s67, 3
  s_mul_i32 s68, s68, 112
  s_lshl_b32 s67, s67, 2
  s_add_u32 s67, s67, s68
  s_add_u32 s67, s67, s3
  s_and_b32 s44, s67, 31
  s_lshr_b32 s45, s67, 5
  s_lshl_b32 s46, s44, 22
  s_mul_i32 s51, s45, 4096
  s_add_u32 s51, s51, s46
  s_mul_i32 s70, s3, 40960
  v_lshlrev_b32 v2, 4, v0
  v_lshrrev_b32 v22, 4, v0
  v_bfe_u32 v23, v0, 2, 2
  v_and_b32 v24, 3, v0
  v_lshlrev_b32 v22, 6, v22
  v_lshlrev_b32 v23, 8, v23
  v_lshlrev_b32 v24, 4, v24
  v_add3_u32 v1, v22, v23, v24
  v_and_b32 v22, 1, v0
  v_lshlrev_b32 v22, 4, v22
  v_mov_b32 v3, 0xffff
  v_lshlrev_b32 v3, v22, v3
  s_mov_b32 s84, 0
  s_mov_b32 s86, 0
  s_mov_b32 s50, s45
  s_mov_b32 s49, 0
  s_mov_b32 s67, s50
  s_cmp_lt_u32 s67, 492
  s_cbranch_scc1 L_decd_1
  s_sub_u32 s67, s67, 492
  s_add_u32 s49, s49, 1
  s_cmp_lt_u32 s67, 492
  s_cbranch_scc1 L_decd_1
  s_sub_u32 s67, s67, 492
  s_add_u32 s49, s49, 1
  s_cmp_lt_u32 s67, 492
  s_cbranch_scc1 L_decd_1
  s_sub_u32 s67, s67, 492
  s_add_u32 s49, s49, 1
  s_cmp_lt_u32 s67, 492
  s_cbranch_scc1 L_decd_1
  s_sub_u32 s67, s67, 492
  s_add_u32 s49, s49, 1
L_decd_1:
  s_mov_b32 s83, 0x10000000
  s_lshl_b32 s48, s67, 12
  s_add_u32 s48, s48, 2179072
  s_add_u32 s48, s48, s46
  s_and_b32 s68, s49, 1
  s_xor_b32 s68, s68, 1
  s_lshl_b32 s68, s68, 27
  s_add_u32 s48, s48, s68
  s_cmp_ge_u32 s49, 4
  s_cselect_b32 s48, 0x10000000, s48
  s_mov_b32 s47, s49
  s_waitcnt lgkmcnt(0)
  s_mov_b32 s28, s6
  s_and_b32 s29, s7, 0xffff
  s_mov_b32 s30, 0x10000000
  s_mov_b32 s31, 0x20000
  s_mov_b32 s32, s8
  s_and_b32 s33, s9, 0xffff
  s_mov_b32 s34, 0x10000000
  s_mov_b32 s35, 0x20000
  buffer_load_dwordx4 v[32:35], v1, s[28:31], s48 offen offset:0 nt
  buffer_load_dwordx4 v[36:39], v1, s[28:31], s48 offen offset:1024 nt
  buffer_load_dwordx4 v[40:43], v1, s[28:31], s48 offen offset:2048 nt
  buffer_load_dwordx4 v[44:47], v1, s[28:31], s48 offen offset:3072 nt
  buffer_load_dwordx4 v[48:51], v2, s[32:35], s48 offen offset:0 nt
  buffer_load_dwordx4 v[52:55], v2, s[32:35], s48 offen offset:1024 nt
  buffer_load_dwordx4 v[56:59], v2, s[32:35], s48 offen offset:2048 nt
  buffer_load_dwordx4 v[60:63], v2, s[32:35], s48 offen offset:3072 nt
  s_mov_b32 s36, s26
  s_and_b32 s37, s27, 0xffff
  s_mov_b32 s38, 0x400000
  s_mov_b32 s39, 0x20000
  s_mov_b32 s40, s24
  s_and_b32 s41, s25, 0xffff
  s_mov_b32 s42, 0x100
  s_mov_b32 s43, 0x20000
  s_add_u32 s50, s45, 28
  v_mov_b32 v0, s50
  s_mov_b32 s52, 0xf000f
  s_mov_b32 s53, 0xf000f
  s_mov_b32 s54, 0xf000f0
  s_mov_b32 s55, 0xf000f0
  s_mov_b32 s56, 0xf000f00
  s_mov_b32 s57, 0xf000f00
  s_mov_b32 s58, 0xf000f000
  s_mov_b32 s59, 0xf000f000
  s_mov_b32 s74, 0x30003
  s_mov_b32 s75, 0x30003
  s_mov_b32 s76, 0xc000c
  s_mov_b32 s77, 0xc000c
  s_mov_b32 s78, 0x300030
  s_mov_b32 s79, 0x300030
  s_mov_b32 s80, 0xc000c0
  s_mov_b32 s81, 0xc000c0
  s_mov_b32 s64, 0x3e0293ee
  v_mov_b32 v8, 0
  v_mov_b32 v9, 0
  v_mov_b32 v10, 0
  v_mov_b32 v11, 0
  s_mov_b32 s72, 0xf149f2ca
  v_mov_b32 v12, 0
  v_mov_b32 v18, 0
  v_mov_b32 v19, 0
  v_mov_b32 v20, 0
  v_mov_b32 v21, 0
  s_mov_b32 s73, 0xf149f2ca
  v_mov_b32 v13, 0
  s_add_u32 s69, s51, 134217728
  s_add_u32 m0, s70, 0
  s_nop 0
  buffer_load_dwordx4 v1, s[28:31], s69 offen offset:0 nt lds
  buffer_load_dwordx4 v1, s[28:31], s69 offen offset:1024 nt lds
  buffer_load_dwordx4 v1, s[28:31], s69 offen offset:2048 nt lds
  buffer_load_dwordx4 v1, s[28:31], s69 offen offset:3072 nt lds
  s_add_u32 m0, s70, 4096
  s_nop 0
  buffer_load_dwordx4 v2, s[32:35], s69 offen offset:0 nt lds
  buffer_load_dwordx4 v2, s[32:35], s69 offen offset:1024 nt lds
  buffer_load_dwordx4 v2, s[32:35], s69 offen offset:2048 nt lds
  buffer_load_dwordx4 v2, s[32:35], s69 offen offset:3072 nt lds
  s_waitcnt vmcnt(4)
  s_add_u32 s69, s51, 134332416
  s_add_u32 m0, s70, 8192
  s_nop 0
  buffer_load_dwordx4 v1, s[28:31], s69 offen offset:0 nt lds
  buffer_load_dwordx4 v1, s[28:31], s69 offen offset:1024 nt lds
  buffer_load_dwordx4 v1, s[28:31], s69 offen offset:2048 nt lds
  buffer_load_dwordx4 v1, s[28:31], s69 offen offset:3072 nt lds
  s_add_u32 m0, s70, 12288
  s_nop 0
  buffer_load_dwordx4 v2, s[32:35], s69 offen offset:0 nt lds
  buffer_load_dwordx4 v2, s[32:35], s69 offen offset:1024 nt lds
  buffer_load_dwordx4 v2, s[32:35], s69 offen offset:2048 nt lds
  buffer_load_dwordx4 v2, s[32:35], s69 offen offset:3072 nt lds
  s_waitcnt vmcnt(4)
  s_add_u32 s69, s51, 134447104
  s_add_u32 m0, s70, 16384
  s_nop 0
  buffer_load_dwordx4 v1, s[28:31], s69 offen offset:0 nt lds
  buffer_load_dwordx4 v1, s[28:31], s69 offen offset:1024 nt lds
  buffer_load_dwordx4 v1, s[28:31], s69 offen offset:2048 nt lds
  buffer_load_dwordx4 v1, s[28:31], s69 offen offset:3072 nt lds
  s_add_u32 m0, s70, 20480
  s_nop 0
  buffer_load_dwordx4 v2, s[32:35], s69 offen offset:0 nt lds
  buffer_load_dwordx4 v2, s[32:35], s69 offen offset:1024 nt lds
  buffer_load_dwordx4 v2, s[32:35], s69 offen offset:2048 nt lds
  buffer_load_dwordx4 v2, s[32:35], s69 offen offset:3072 nt lds
  s_waitcnt vmcnt(4)
  s_add_u32 s69, s51, 134561792
  s_add_u32 m0, s70, 24576
  s_nop 0
  buffer_load_dwordx4 v1, s[28:31], s69 offen offset:0 nt lds
  buffer_load_dwordx4 v1, s[28:31], s69 offen offset:1024 nt lds
  buffer_load_dwordx4 v1, s[28:31], s69 offen offset:2048 nt lds
  buffer_load_dwordx4 v1, s[28:31], s69 offen offset:3072 nt lds
  s_add_u32 m0, s70, 28672
  s_nop 0
  buffer_load_dwordx4 v2, s[32:35], s69 offen offset:0 nt lds
  buffer_load_dwordx4 v2, s[32:35], s69 offen offset:1024 nt lds
  buffer_load_dwordx4 v2, s[32:35], s69 offen offset:2048 nt lds
  buffer_load_dwordx4 v2, s[32:35], s69 offen offset:3072 nt lds
  s_waitcnt vmcnt(4)
  s_add_u32 s69, s51, 134676480
  s_add_u32 m0, s70, 32768
  s_nop 0
  buffer_load_dwordx4 v1, s[28:31], s69 offen offset:0 nt lds
  buffer_load_dwordx4 v1, s[28:31], s69 offen offset:1024 nt lds
  buffer_load_dwordx4 v1, s[28:31], s69 offen offset:2048 nt lds
  buffer_load_dwordx4 v1, s[28:31], s69 offen offset:3072 nt lds
  s_add_u32 m0, s70, 36864
  s_nop 0
  buffer_load_dwordx4 v2, s[32:35], s69 offen offset:0 nt lds
  buffer_load_dwordx4 v2, s[32:35], s69 offen offset:1024 nt lds
  buffer_load_dwordx4 v2, s[32:35], s69 offen offset:2048 nt lds
  buffer_load_dwordx4 v2, s[32:35], s69 offen offset:3072 nt lds
  s_waitcnt vmcnt(4)
  s_add_u32 s69, s51, 134791168
  buffer_load_dwordx4 v[64:67], v1, s[28:31], s69 offen offset:0 nt
  buffer_load_dwordx4 v[68:71], v1, s[28:31], s69 offen offset:1024 nt
  buffer_load_dwordx4 v[72:75], v1, s[28:31], s69 offen offset:2048 nt
  buffer_load_dwordx4 v[76:79], v1, s[28:31], s69 offen offset:3072 nt
  buffer_load_dwordx4 v[80:83], v2, s[32:35], s69 offen offset:0 nt
  buffer_load_dwordx4 v[84:87], v2, s[32:35], s69 offen offset:1024 nt
  buffer_load_dwordx4 v[88:91], v2, s[32:35], s69 offen offset:2048 nt
  buffer_load_dwordx4 v[92:95], v2, s[32:35], s69 offen offset:3072 nt
  s_waitcnt vmcnt(4)
  s_add_u32 s69, s51, 134905856
  buffer_load_dwordx4 v[96:99], v1, s[28:31], s69 offen offset:0 nt
  buffer_load_dwordx4 v[100:103], v1, s[28:31], s69 offen offset:1024 nt
  buffer_load_dwordx4 v[104:107], v1, s[28:31], s69 offen offset:2048 nt
  buffer_load_dwordx4 v[108:111], v1, s[28:31], s69 offen offset:3072 nt
  buffer_load_dwordx4 v[112:115], v2, s[32:35], s69 offen offset:0 nt
  buffer_load_dwordx4 v[116:119], v2, s[32:35], s69 offen offset:1024 nt
  buffer_load_dwordx4 v[120:123], v2, s[32:35], s69 offen offset:2048 nt
  buffer_load_dwordx4 v[124:127], v2, s[32:35], s69 offen offset:3072 nt
  s_waitcnt vmcnt(4)
  s_add_u32 s69, s51, 135020544
  buffer_load_dwordx4 v[128:131], v1, s[28:31], s69 offen offset:0 nt
  buffer_load_dwordx4 v[132:135], v1, s[28:31], s69 offen offset:1024 nt
  buffer_load_dwordx4 v[136:139], v1, s[28:31], s69 offen offset:2048 nt
  buffer_load_dwordx4 v[140:143], v1, s[28:31], s69 offen offset:3072 nt
  buffer_load_dwordx4 v[144:147], v2, s[32:35], s69 offen offset:0 nt
  buffer_load_dwordx4 v[148:151], v2, s[32:35], s69 offen offset:1024 nt
  buffer_load_dwordx4 v[152:155], v2, s[32:35], s69 offen offset:2048 nt
  buffer_load_dwordx4 v[156:159], v2, s[32:35], s69 offen offset:3072 nt
  s_waitcnt vmcnt(4)
  s_add_u32 s69, s51, 135135232
  buffer_load_dwordx4 v[160:163], v1, s[28:31], s69 offen offset:0 nt
  buffer_load_dwordx4 v[164:167], v1, s[28:31], s69 offen offset:1024 nt
  buffer_load_dwordx4 v[168:171], v1, s[28:31], s69 offen offset:2048 nt
  buffer_load_dwordx4 v[172:175], v1, s[28:31], s69 offen offset:3072 nt
  buffer_load_dwordx4 v[176:179], v2, s[32:35], s69 offen offset:0 nt
  buffer_load_dwordx4 v[180:183], v2, s[32:35], s69 offen offset:1024 nt
  buffer_load_dwordx4 v[184:187], v2, s[32:35], s69 offen offset:2048 nt
  buffer_load_dwordx4 v[188:191], v2, s[32:35], s69 offen offset:3072 nt
  s_waitcnt vmcnt(4)
  s_add_u32 s69, s51, 135249920
  buffer_load_dwordx4 v[192:195], v1, s[28:31], s69 offen offset:0 nt
  buffer_load_dwordx4 v[196:199], v1, s[28:31], s69 offen offset:1024 nt
  buffer_load_dwordx4 v[200:203], v1, s[28:31], s69 offen offset:2048 nt
  buffer_load_dwordx4 v[204:207], v1, s[28:31], s69 offen offset:3072 nt
  buffer_load_dwordx4 v[208:211], v2, s[32:35], s69 offen offset:0 nt
  buffer_load_dwordx4 v[212:215], v2, s[32:35], s69 offen offset:1024 nt
  buffer_load_dwordx4 v[216:219], v2, s[32:35], s69 offen offset:2048 nt
  buffer_load_dwordx4 v[220:223], v2, s[32:35], s69 offen offset:3072 nt
  s_waitcnt vmcnt(4)
  s_add_u32 s69, s51, 135364608
  buffer_load_dwordx4 v[224:227], v1, s[28:31], s69 offen offset:0 nt
  buffer_load_dwordx4 v[228:231], v1, s[28:31], s69 offen offset:1024 nt
  buffer_load_dwordx4 v[232:235], v1, s[28:31], s69 offen offset:2048 nt
  buffer_load_dwordx4 v[236:239], v1, s[28:31], s69 offen offset:3072 nt
  buffer_load_dwordx4 v[240:243], v2, s[32:35], s69 offen offset:0 nt
  buffer_load_dwordx4 v[244:247], v2, s[32:35], s69 offen offset:1024 nt
  buffer_load_dwordx4 v[248:251], v2, s[32:35], s69 offen offset:2048 nt
  buffer_load_dwordx4 v[252:255], v2, s[32:35], s69 offen offset:3072 nt
  s_waitcnt vmcnt(4)
  s_add_u32 s69, s51, 135479296
  buffer_load_dwordx4 a[0:3], v1, s[28:31], s69 offen offset:0 nt
  buffer_load_dwordx4 a[4:7], v1, s[28:31], s69 offen offset:1024 nt
  buffer_load_dwordx4 a[8:11], v1, s[28:31], s69 offen offset:2048 nt
  buffer_load_dwordx4 a[12:15], v1, s[28:31], s69 offen offset:3072 nt
  buffer_load_dwordx4 a[16:19], v2, s[32:35], s69 offen offset:0 nt
  buffer_load_dwordx4 a[20:23], v2, s[32:35], s69 offen offset:1024 nt
  buffer_load_dwordx4 a[24:27], v2, s[32:35], s69 offen offset:2048 nt
  buffer_load_dwordx4 a[28:31], v2, s[32:35], s69 offen offset:3072 nt
  s_waitcnt vmcnt(4)
  v_mov_b32 v30, 0
  s_mov_b32 exec_lo, 0
  s_mov_b32 exec_hi, 0x80000000
  buffer_load_dword v0, v30, s[40:43], 0 offen sc1
  s_mov_b64 exec, -1
  s_add_u32 s69, s51, 135593984
  buffer_load_dwordx4 a[32:35], v1, s[28:31], s69 offen offset:0 nt
  buffer_load_dwordx4 a[36:39], v1, s[28:31], s69 offen offset:1024 nt
  buffer_load_dwordx4 a[40:43], v1, s[28:31], s69 offen offset:2048 nt
  buffer_load_dwordx4 a[44:47], v1, s[28:31], s69 offen offset:3072 nt
  buffer_load_dwordx4 a[48:51], v2, s[32:35], s69 offen offset:0 nt
  buffer_load_dwordx4 a[52:55], v2, s[32:35], s69 offen offset:1024 nt
  buffer_load_dwordx4 a[56:59], v2, s[32:35], s69 offen offset:2048 nt
  buffer_load_dwordx4 a[60:63], v2, s[32:35], s69 offen offset:3072 nt
  s_waitcnt vmcnt(4)
  s_mov_b32 s98, 0
L_fl_2:
  v_readlane_b32 s97, v0, 63
  s_cmp_ge_u32 s97, 32
  s_cbranch_scc1 L_fld_3
  s_add_u32 s98, s98, 1
  s_cmp_gt_u32 s98, 400000
  s_cbranch_scc1 L_fld_3_to
  s_cmp_lg_u32 s99, 0
  s_cbranch_scc1 L_fld_3
  s_sleep 8
  v_mov_b32 v30, 0
  s_mov_b32 exec_lo, 0
  s_mov_b32 exec_hi, 0x80000000
  buffer_load_dword v0, v30, s[40:43], 0 offen sc1
  s_mov_b64 exec, -1
  s_waitcnt vmcnt(0)
  s_branch L_fl_2
L_fld_3_to:
  s_mov_b32 s99, 1
L_fld_3:
  s_lshl_b32 s67, s44, 8
  s_add_u32 s67, s67, 8192
  v_and_b32 v30, 0xff, v1
  buffer_load_dwordx4 v[14:17], v30, s[36:39], s67 offen sc1
  s_add_u32 s69, s51, 135708672
  buffer_load_dwordx4 a[64:67], v1, s[28:31], s69 offen offset:0 nt
  buffer_load_dwordx4 a[68:71], v1, s[28:31], s69 offen offset:1024 nt
  buffer_load_dwordx4 a[72:75], v1, s[28:31], s69 offen offset:2048 nt
  buffer_load_dwordx4 a[76:79], v1, s[28:31], s69 offen offset:3072 nt
  buffer_load_dwordx4 a[80:83], v2, s[32:35], s69 offen offset:0 nt
  buffer_load_dwordx4 a[84:87], v2, s[32:35], s69 offen offset:1024 nt
  buffer_load_dwordx4 a[88:91], v2, s[32:35], s69 offen offset:2048 nt
  buffer_load_dwordx4 a[92:95], v2, s[32:35], s69 offen offset:3072 nt
  s_waitcnt vmcnt(4)
  s_mov_b32 s98, 0
L_qpoll_4:
  v_max_u32 v30, v14, v15
  v_max3_u32 v30, v30, v16, v17
  v_cmp_eq_u32 vcc, -1, v30
  s_nop 4
  s_cbranch_vccz L_qdone_5
  s_add_u32 s98, s98, 1
  s_cmp_gt_u32 s98, 400000
  s_cbranch_scc1 L_qdone_5_to
  s_cmp_lg_u32 s99, 0
  s_cbranch_scc1 L_qdone_5
  s_sleep 4
  s_lshl_b32 s67, s44, 8
  s_add_u32 s67, s67, 8192
  v_and_b32 v30, 0xff, v1
  buffer_load_dwordx4 v[14:17], v30, s[36:39], s67 offen sc1
  s_waitcnt vmcnt(0)
  s_branch L_qpoll_4
L_qdone_5_to:
  s_mov_b32 s99, 1
L_qdone_5:
  v_mov_b32 v4, v14
  v_mov_b32 v5, v15
  v_mov_b32 v6, v16
  v_mov_b32 v7, v17
  v_mov_b32 v30, 4
  s_mov_b32 exec_lo, 0
  s_mov_b32 exec_hi, 0x80000000
  buffer_load_dword v0, v30, s[40:43], 0 offen sc1
  s_mov_b64 exec, -1
  s_call_b64 s[60:61], L_proc_F0_X
  s_add_u32 s69, s51, 135823360
  buffer_load_dwordx4 a[96:99], v1, s[28:31], s69 offen offset:0 nt
  buffer_load_dwordx4 a[100:103], v1, s[28:31], s69 offen offset:1024 nt
  buffer_load_dwordx4 a[104:107], v1, s[28:31], s69 offen offset:2048 nt
  buffer_load_dwordx4 a[108:111], v1, s[28:31], s69 offen offset:3072 nt
  buffer_load_dwordx4 a[112:115], v2, s[32:35], s69 offen offset:0 nt
  buffer_load_dwordx4 a[116:119], v2, s[32:35], s69 offen offset:1024 nt
  buffer_load_dwordx4 a[120:123], v2, s[32:35], s69 offen offset:2048 nt
  buffer_load_dwordx4 a[124:127], v2, s[32:35], s69 offen offset:3072 nt
  s_waitcnt vmcnt(4)
  s_mov_b32 s98, 0
L_fl_6:
  v_readlane_b32 s97, v0, 63
  s_cmp_ge_u32 s97, 32
  s_cbranch_scc1 L_fld_7
  s_add_u32 s98, s98, 1
  s_cmp_gt_u32 s98, 400000
  s_cbranch_scc1 L_fld_7_to
  s_cmp_lg_u32 s99, 0
  s_cbranch_scc1 L_fld_7
  s_sleep 8
  v_mov_b32 v30, 4
  s_mov_b32 exec_lo, 0
  s_mov_b32 exec_hi, 0x80000000
  buffer_load_dword v0, v30, s[40:43], 0 offen sc1
  s_mov_b64 exec, -1
  s_waitcnt vmcnt(0)
  s_branch L_fl_6
L_fld_7_to:
  s_mov_b32 s99, 1
L_fld_7:
  s_add_u32 s69, s51, 135938048
  buffer_load_dwordx4 a[128:131], v1, s[28:31], s69 offen offset:0 nt
  buffer_load_dwordx4 a[132:135], v1, s[28:31], s69 offen offset:1024 nt
  buffer_load_dwordx4 a[136:139], v1, s[28:31], s69 offen offset:2048 nt
  buffer_load_dwordx4 a[140:143], v1, s[28:31], s69 offen offset:3072 nt
  buffer_load_dwordx4 a[144:147], v2, s[32:35], s69 offen offset:0 nt
  buffer_load_dwordx4 a[148:151], v2, s[32:35], s69 offen offset:1024 nt
  buffer_load_dwordx4 a[152:155], v2, s[32:35], s69 offen offset:2048 nt
  buffer_load_dwordx4 a[156:159], v2, s[32:35], s69 offen offset:3072 nt
  v_add_u32 v30, s70, v2
  ds_read_b128 v[32:35], v30 offset:0
  ds_read_b128 v[36:39], v30 offset:1024
  ds_read_b128 v[40:43], v30 offset:2048
  ds_read_b128 v[44:47], v30 offset:3072
  ds_read_b128 v[48:51], v30 offset:4096
  ds_read_b128 v[52:55], v30 offset:5120
  ds_read_b128 v[56:59], v30 offset:6144
  ds_read_b128 v[60:63], v30 offset:7168
  s_waitcnt lgkmcnt(0)
  s_call_b64 s[60:61], L_proc_F0_Y
  v_add_u32 v30, s70, v2
  ds_read_b128 v[32:35], v30 offset:8192
  ds_read_b128 v[36:39], v30 offset:9216
  ds_read_b128 v[40:43], v30 offset:10240
  ds_read_b128 v[44:47], v30 offset:11264
  ds_read_b128 v[48:51], v30 offset:12288
  ds_read_b128 v[52:55], v30 offset:13312
  ds_read_b128 v[56:59], v30 offset:14336
  ds_read_b128 v[60:63], v30 offset:15360
  s_waitcnt lgkmcnt(0)
  s_call_b64 s[60:61], L_proc_F0_Y
  s_waitcnt vmcnt(4)
  s_add_u32 s69, s51, 136052736
  buffer_load_dwordx4 a[160:163], v1, s[28:31], s69 offen offset:0 nt
  buffer_load_dwordx4 a[164:167], v1, s[28:31], s69 offen offset:1024 nt
  buffer_load_dwordx4 a[168:171], v1, s[28:31], s69 offen offset:2048 nt
  buffer_load_dwordx4 a[172:175], v1, s[28:31], s69 offen offset:3072 nt
  buffer_load_dwordx4 a[176:179], v2, s[32:35], s69 offen offset:0 nt
  buffer_load_dwordx4 a[180:183], v2, s[32:35], s69 offen offset:1024 nt
  buffer_load_dwordx4 a[184:187], v2, s[32:35], s69 offen offset:2048 nt
  buffer_load_dwordx4 a[188:191], v2, s[32:35], s69 offen offset:3072 nt
  v_add_u32 v30, s70, v2
  ds_read_b128 v[32:35], v30 offset:16384
  ds_read_b128 v[36:39], v30 offset:17408
  ds_read_b128 v[40:43], v30 offset:18432
  ds_read_b128 v[44:47], v30 offset:19456
  ds_read_b128 v[48:51], v30 offset:20480
  ds_read_b128 v[52:55], v30 offset:21504
  ds_read_b128 v[56:59], v30 offset:22528
  ds_read_b128 v[60:63], v30 offset:23552
  s_waitcnt lgkmcnt(0)
  s_call_b64 s[60:61], L_proc_F0_Y
  v_add_u32 v30, s70, v2
  ds_read_b128 v[32:35], v30 offset:24576
  ds_read_b128 v[36:39], v30 offset:25600
  ds_read_b128 v[40:43], v30 offset:26624
  ds_read_b128 v[44:47], v30 offset:27648
  ds_read_b128 v[48:51], v30 offset:28672
  ds_read_b128 v[52:55], v30 offset:29696
  ds_read_b128 v[56:59], v30 offset:30720
  ds_read_b128 v[60:63], v30 offset:31744
  s_waitcnt lgkmcnt(0)
  s_call_b64 s[60:61], L_proc_F0_Y
  s_waitcnt vmcnt(4)
  s_add_u32 s69, s51, 136167424
  buffer_load_dwordx4 a[192:195], v1, s[28:31], s69 offen offset:0 nt
  buffer_load_dwordx4 a[196:199], v1, s[28:31], s69 offen offset:1024 nt
  buffer_load_dwordx4 a[200:203], v1, s[28:31], s69 offen offset:2048 nt
  buffer_load_dwordx4 a[204:207], v1, s[28:31], s69 offen offset:3072 nt
  buffer_load_dwordx4 a[208:211], v2, s[32:35], s69 offen offset:0 nt
  buffer_load_dwordx4 a[212:215], v2, s[32:35], s69 offen offset:1024 nt
  buffer_load_dwordx4 a[216:219], v2, s[32:35], s69 offen offset:2048 nt
  buffer_load_dwordx4 a[220:223], v2, s[32:35], s69 offen offset:3072 nt
  v_add_u32 v30, s70, v2
  ds_read_b128 v[32:35], v30 offset:32768
  ds_read_b128 v[36:39], v30 offset:33792
  ds_read_b128 v[40:43], v30 offset:34816
  ds_read_b128 v[44:47], v30 offset:35840
  ds_read_b128 v[48:51], v30 offset:36864
  ds_read_b128 v[52:55], v30 offset:37888
  ds_read_b128 v[56:59], v30 offset:38912
  ds_read_b128 v[60:63], v30 offset:39936
  s_waitcnt lgkmcnt(0)
  s_call_b64 s[60:61], L_proc_F0_Y
  s_call_b64 s[60:61], L_proc_S0_Y
  s_waitcnt vmcnt(4)
  s_add_u32 s69, s51, 136282112
  buffer_load_dwordx4 a[224:227], v1, s[28:31], s69 offen offset:0 nt
  buffer_load_dwordx4 a[228:231], v1, s[28:31], s69 offen offset:1024 nt
  buffer_load_dwordx4 a[232:235], v1, s[28:31], s69 offen offset:2048 nt
  buffer_load_dwordx4 a[236:239], v1, s[28:31], s69 offen offset:3072 nt
  buffer_load_dwordx4 a[240:243], v2, s[32:35], s69 offen offset:0 nt
  buffer_load_dwordx4 a[244:247], v2, s[32:35], s69 offen offset:1024 nt
  buffer_load_dwordx4 a[248:251], v2, s[32:35], s69 offen offset:2048 nt
  buffer_load_dwordx4 a[252:255], v2, s[32:35], s69 offen offset:3072 nt
  s_call_b64 s[60:61], L_proc_S1_Y
  s_call_b64 s[60:61], L_proc_S2_Y
  v_readfirstlane_b32 s50, v0
  s_nop 3
  s_mov_b32 s49, 0
  s_mov_b32 s67, s50
  s_cmp_lt_u32 s67, 492
  s_cbranch_scc1 L_decd_8
  s_sub_u32 s67, s67, 492
  s_add_u32 s49, s49, 1
  s_cmp_lt_u32 s67, 492
  s_cbranch_scc1 L_decd_8
  s_sub_u32 s67, s67, 492
  s_add_u32 s49, s49, 1
  s_cmp_lt_u32 s67, 492
  s_cbranch_scc1 L_decd_8
  s_sub_u32 s67, s67, 492
  s_add_u32 s49, s49, 1
  s_cmp_lt_u32 s67, 492
  s_cbranch_scc1 L_decd_8
  s_sub_u32 s67, s67, 492
  s_add_u32 s49, s49, 1
L_decd_8:
  s_mov_b32 s83, 0x10000000
  s_lshl_b32 s48, s67, 12
  s_add_u32 s48, s48, 2179072
  s_add_u32 s48, s48, s46
  s_and_b32 s68, s49, 1
  s_xor_b32 s68, s68, 1
  s_lshl_b32 s68, s68, 27
  s_add_u32 s48, s48, s68
  s_cmp_ge_u32 s49, 4
  s_cselect_b32 s48, 0x10000000, s48
  v_mov_b32 v0, 1
  s_lshl_b32 s67, s44, 8
  v_mov_b32 v30, 0
  s_mov_b64 exec, 1
  buffer_atomic_add v0, v30, s[36:39], s67 offen sc0 sc1
  s_mov_b64 exec, -1
  buffer_load_dwordx4 v[32:35], v1, s[28:31], s48 offen offset:0 nt
  buffer_load_dwordx4 v[36:39], v1, s[28:31], s48 offen offset:1024 nt
  buffer_load_dwordx4 v[40:43], v1, s[28:31], s48 offen offset:2048 nt
  buffer_load_dwordx4 v[44:47], v1, s[28:31], s48 offen offset:3072 nt
  buffer_load_dwordx4 v[48:51], v2, s[32:35], s48 offen offset:0 nt
  buffer_load_dwordx4 v[52:55], v2, s[32:35], s48 offen offset:1024 nt
  buffer_load_dwordx4 v[56:59], v2, s[32:35], s48 offen offset:2048 nt
  buffer_load_dwordx4 v[60:63], v2, s[32:35], s48 offen offset:3072 nt
  s_mov_b32 s47, s49
  s_call_b64 s[60:61], L_proc_S3_Y
  s_call_b64 s[60:61], L_proc_S4_Y
  s_cmp_lg_u32 s47, 0
  s_cbranch_scc1 L_pif_9
  s_call_b64 s[62:63], L_pair_step
L_pif_9:
  s_call_b64 s[60:61], L_proc_S5_Y
  s_call_b64 s[60:61], L_proc_S6_Y
  s_cmp_lg_u32 s47, 0
  s_cbranch_scc1 L_pif_10
  s_call_b64 s[62:63], L_pair_step
L_pif_10:
  s_call_b64 s[60:61], L_proc_S7_Y
  s_call_b64 s[60:61], L_proc_S8_Y
  s_cmp_lg_u32 s47, 0
  s_cbranch_scc1 L_pif_11
  s_call_b64 s[62:63], L_pair_step
L_pif_11:
  s_call_b64 s[60:61], L_proc_S9_Y
  s_call_b64 s[60:61], L_proc_S10_Y
  s_cmp_lg_u32 s47, 0
  s_cbranch_scc1 L_pif_12
  s_call_b64 s[62:63], L_pair_step
L_pif_12:
  s_call_b64 s[60:61], L_proc_S11_Y
  s_waitcnt vmcnt(17)
  s_call_b64 s[60:61], L_proc_S12_Y
  s_cmp_lg_u32 s47, 0
  s_cbranch_scc1 L_pif_13
  s_call_b64 s[62:63], L_pair_step
L_pif_13:
  s_waitcnt vmcnt(9)
  s_call_b64 s[60:61], L_proc_S13_Y
  s_nop 7
  v_mov_b32 v30, s72
  v_mov_b32 v22, s73
  v_max_f32 v31, v30, v22
  v_sub_f32 v30, v30, v31
  v_sub_f32 v22, v22, v31
  v_exp_f32 v30, v30
  v_exp_f32 v22, v22
  v_readfirstlane_b32 s72, v31
  v_mul_f32 v8, v30, v8
  v_fmac_f32 v8, v22, v18
  v_mul_f32 v9, v30, v9
  v_fmac_f32 v9, v22, v19
  v_mul_f32 v10, v30, v10
  v_fmac_f32 v10, v22, v20
  v_mul_f32 v11, v30, v11
  v_fmac_f32 v11, v22, v21
  v_mul_f32 v12, v30, v12
  v_fmac_f32 v12, v22, v13
  s_mov_b32 s71, 0
L_pool0:
  s_cmp_lg_u32 s47, 0
  s_cbranch_scc1 L_pool0_end
  s_call_b64 s[62:63], L_pair_step
  s_cmp_eq_u32 s71, 2
  s_cbranch_scc1 L_pool0
  s_cmp_eq_u32 s71, 0
  s_cbranch_scc1 L_pqi_15
  s_waitcnt vmcnt(9)
  v_max_u32 v30, v14, v15
  v_max3_u32 v30, v30, v16, v17
  v_cmp_eq_u32 vcc, -1, v30
  s_nop 4
  s_cbranch_vccnz L_pqi_15
  s_mov_b32 s71, 2
  s_branch L_pool0
L_pqi_15:
  s_lshl_b32 s67, s44, 8
  s_add_u32 s67, s67, 16384
  v_and_b32 v30, 0xff, v1
  buffer_load_dwordx4 v[14:17], v30, s[36:39], s67 offen sc1
  s_mov_b32 s71, 1
  s_branch L_pool0
L_pool0_end:
  s_cmp_eq_u32 s71, 2
  s_cbranch_scc1 L_pqd_16
  s_lshl_b32 s67, s44, 8
  s_add_u32 s67, s67, 16384
  v_and_b32 v30, 0xff, v1
  buffer_load_dwordx4 v[14:17], v30, s[36:39], s67 offen sc1
  s_waitcnt vmcnt(0)
  s_mov_b32 s98, 0
L_qpoll_17:
  v_max_u32 v30, v14, v15
  v_max3_u32 v30, v30, v16, v17
  v_cmp_eq_u32 vcc, -1, v30
  s_nop 4
  s_cbranch_vccz L_qdone_18
  s_add_u32 s98, s98, 1
  s_cmp_gt_u32 s98, 400000
  s_cbranch_scc1 L_qdone_18_to
  s_cmp_lg_u32 s99, 0
  s_cbranch_scc1 L_qdone_18
  s_sleep 4
  s_lshl_b32 s67, s44, 8
  s_add_u32 s67, s67, 16384
  v_and_b32 v30, 0xff, v1
  buffer_load_dwordx4 v[14:17], v30, s[36:39], s67 offen sc1
  s_waitcnt vmcnt(0)
  s_branch L_qpoll_17
L_qdone_18_to:
  s_mov_b32 s99, 1
L_qdone_18:
L_pqd_16:
  s_nop 7
  v_mov_b32 v30, v12
  s_nop 1
  v_add_f32_dpp v30, v30, v30 row_ror:4 row_mask:0xf bank_mask:0xf
  s_nop 1
  v_add_f32_dpp v30, v30, v30 row_ror:8 row_mask:0xf bank_mask:0xf
  s_nop 1
  v_add_f32_dpp v30, v30, v30 row_bcast:15 row_mask:0xa bank_mask:0xf
  s_nop 1
  v_add_f32_dpp v30, v30, v30 row_bcast:31 row_mask:0xc bank_mask:0xf
  s_nop 0
  v_readlane_b32 s66, v30, 63
  v_and_b32 v31, 0xf0, v2
  v_lshlrev_b32 v31, 1, v31
  v_lshrrev_b32 v22, 4, v2
  v_and_b32 v22, 0x10, v22
  v_add_u32 v31, v31, v22
  v_cmp_gt_u32 vcc, 512, v2
  s_nop 1
  v_cndmask_b32 v31, v2, v31, vcc
  v_writelane_b32 v8, s72, 32
  v_writelane_b32 v9, s66, 32
  s_mul_i32 s67, s44, 28
  s_add_u32 s67, s67, s45
  s_mul_i32 s67, s67, 640
  s_add_u32 s67, s67, 589824
  s_mov_b32 exec_hi, 0xff
  buffer_store_dwordx4 v[8:11], v31, s[36:39], s67 offen sc0 sc1
  s_mov_b32 exec_hi, -1
  s_nop 1
  v_mov_b32 v4, v14
  v_mov_b32 v5, v15
  v_mov_b32 v6, v16
  v_mov_b32 v7, v17
  v_mov_b32 v8, 0
  v_mov_b32 v9, 0
  v_mov_b32 v10, 0
  v_mov_b32 v11, 0
  s_mov_b32 s72, 0xf149f2ca
  v_mov_b32 v12, 0
  s_mov_b32 s71, 0
L_pool1:
  s_cmp_lg_u32 s47, 1
  s_cbranch_scc1 L_pool1_end
  s_call_b64 s[62:63], L_pair_step
  s_cmp_eq_u32 s71, 2
  s_cbranch_scc1 L_pool1
  s_cmp_eq_u32 s71, 0
  s_cbranch_scc1 L_pqi_20
  s_waitcnt vmcnt(9)
  v_max_u32 v30, v14, v15
  v_max3_u32 v30, v30, v16, v17
  v_cmp_eq_u32 vcc, -1, v30
  s_nop 4
  s_cbranch_vccnz L_pqi_20
  s_mov_b32 s71, 2
  s_branch L_pool1
L_pqi_20:
  s_lshl_b32 s67, s44, 8
  s_add_u32 s67, s67, 24576
  v_and_b32 v30, 0xff, v1
  buffer_load_dwordx4 v[14:17], v30, s[36:39], s67 offen sc1
  s_mov_b32 s71, 1
  s_branch L_pool1
L_pool1_end:
  s_cmp_eq_u32 s71, 2
  s_cbranch_scc1 L_pqd_21
  s_lshl_b32 s67, s44, 8
  s_add_u32 s67, s67, 24576
  v_and_b32 v30, 0xff, v1
  buffer_load_dwordx4 v[14:17], v30, s[36:39], s67 offen sc1
  s_waitcnt vmcnt(0)
  s_mov_b32 s98, 0
L_qpoll_22:
  v_max_u32 v30, v14, v15
  v_max3_u32 v30, v30, v16, v17
  v_cmp_eq_u32 vcc, -1, v30
  s_nop 4
  s_cbranch_vccz L_qdone_23
  s_add_u32 s98, s98, 1
  s_cmp_gt_u32 s98, 400000
  s_cbranch_scc1 L_qdone_23_to
  s_cmp_lg_u32 s99, 0
  s_cbranch_scc1 L_qdone_23
  s_sleep 4
  s_lshl_b32 s67, s44, 8
  s_add_u32 s67, s67, 24576
  v_and_b32 v30, 0xff, v1
  buffer_load_dwordx4 v[14:17], v30, s[36:39], s67 offen sc1
  s_waitcnt vmcnt(0)
  s_branch L_qpoll_22
L_qdone_23_to:
  s_mov_b32 s99, 1
L_qdone_23:
L_pqd_21:
  v_mov_b32 v18, 0
  v_mov_b32 v19, 0
  v_mov_b32 v20, 0
  v_mov_b32 v21, 0
  s_mov_b32 s73, 0xf149f2ca
  v_mov_b32 v13, 0
  s_call_b64 s[60:61], L_proc_S0_Y
  v_add_u32 v30, s70, v2
  ds_read_b128 v[64:67], v30 offset:0
  ds_read_b128 v[68:71], v30 offset:1024
  ds_read_b128 v[72:75], v30 offset:2048
  ds_read_b128 v[76:79], v30 offset:3072
  ds_read_b128 v[80:83], v30 offset:4096
  ds_read_b128 v[84:87], v30 offset:5120
  ds_read_b128 v[88:91], v30 offset:6144
  ds_read_b128 v[92:95], v30 offset:7168
  s_waitcnt lgkmcnt(0)
  s_call_b64 s[60:61], L_proc_S0_Y
  s_waitcnt vmcnt(4)
  s_add_u32 s69, s51, 0
  s_add_u32 m0, s70, 0
  s_nop 0
  buffer_load_dwordx4 v1, s[28:31], s69 offen offset:0 nt lds
  buffer_load_dwordx4 v1, s[28:31], s69 offen offset:1024 nt lds
  buffer_load_dwordx4 v1, s[28:31], s69 offen offset:2048 nt lds
  buffer_load_dwordx4 v1, s[28:31], s69 offen offset:3072 nt lds
  s_add_u32 m0, s70, 4096
  s_nop 0
  buffer_load_dwordx4 v2, s[32:35], s69 offen offset:0 nt lds
  buffer_load_dwordx4 v2, s[32:35], s69 offen offset:1024 nt lds
  buffer_load_dwordx4 v2, s[32:35], s69 offen offset:2048 nt lds
  buffer_load_dwordx4 v2, s[32:35], s69 offen offset:3072 nt lds
  s_waitcnt vmcnt(4)
  s_add_u32 s69, s51, 573440
  buffer_load_dwordx4 v[64:67], v1, s[28:31], s69 offen offset:0 nt
  buffer_load_dwordx4 v[68:71], v1, s[28:31], s69 offen offset:1024 nt
  buffer_load_dwordx4 v[72:75], v1, s[28:31], s69 offen offset:2048 nt
  buffer_load_dwordx4 v[76:79], v1, s[28:31], s69 offen offset:3072 nt
  buffer_load_dwordx4 v[80:83], v2, s[32:35], s69 offen offset:0 nt
  buffer_load_dwordx4 v[84:87], v2, s[32:35], s69 offen offset:1024 nt
  buffer_load_dwordx4 v[88:91], v2, s[32:35], s69 offen offset:2048 nt
  buffer_load_dwordx4 v[92:95], v2, s[32:35], s69 offen offset:3072 nt
  s_call_b64 s[60:61], L_proc_S1_Y
  v_add_u32 v30, s70, v2
  ds_read_b128 v[96:99], v30 offset:8192
  ds_read_b128 v[100:103], v30 offset:9216
  ds_read_b128 v[104:107], v30 offset:10240
  ds_read_b128 v[108:111], v30 offset:11264
  ds_read_b128 v[112:115], v30 offset:12288
  ds_read_b128 v[116:119], v30 offset:13312
  ds_read_b128 v[120:123], v30 offset:14336
  ds_read_b128 v[124:127], v30 offset:15360
  s_waitcnt lgkmcnt(0)
  s_call_b64 s[60:61], L_proc_S1_Y
  s_waitcnt vmcnt(4)
  s_add_u32 s69, s51, 114688
  s_add_u32 m0, s70, 8192
  s_nop 0
  buffer_load_dwordx4 v1, s[28:31], s69 offen offset:0 nt lds
  buffer_load_dwordx4 v1, s[28:31], s69 offen offset:1024 nt lds
  buffer_load_dwordx4 v1, s[28:31], s69 offen offset:2048 nt lds
  buffer_load_dwordx4 v1, s[28:31], s69 offen offset:3072 nt lds
  s_add_u32 m0, s70, 12288
  s_nop 0
  buffer_load_dwordx4 v2, s[32:35], s69 offen offset:0 nt lds
  buffer_load_dwordx4 v2, s[32:35], s69 offen offset:1024 nt lds
  buffer_load_dwordx4 v2, s[32:35], s69 offen offset:2048 nt lds
  buffer_load_dwordx4 v2, s[32:35], s69 offen offset:3072 nt lds
  s_waitcnt vmcnt(4)
  s_add_u32 s69, s51, 688128
  buffer_load_dwordx4 v[96:99], v1, s[28:31], s69 offen offset:0 nt
  buffer_load_dwordx4 v[100:103], v1, s[28:31], s69 offen offset:1024 nt
  buffer_load_dwordx4 v[104:107], v1, s[28:31], s69 offen offset:2048 nt
  buffer_load_dwordx4 v[108:111], v1, s[28:31], s69 offen offset:3072 nt
  buffer_load_dwordx4 v[112:115], v2, s[32:35], s69 offen offset:0 nt
  buffer_load_dwordx4 v[116:119], v2, s[32:35], s69 offen offset:1024 nt
  buffer_load_dwordx4 v[120:123], v2, s[32:35], s69 offen offset:2048 nt
  buffer_load_dwordx4 v[124:127], v2, s[32:35], s69 offen offset:3072 nt
  s_call_b64 s[60:61], L_proc_S0_X
  s_call_b64 s[60:61], L_proc_S2_Y
  v_add_u32 v30, s70, v2
  ds_read_b128 v[128:131], v30 offset:16384
  ds_read_b128 v[132:135], v30 offset:17408
  ds_read_b128 v[136:139], v30 offset:18432
  ds_read_b128 v[140:143], v30 offset:19456
  ds_read_b128 v[144:147], v30 offset:20480
  ds_read_b128 v[148:151], v30 offset:21504
  ds_read_b128 v[152:155], v30 offset:22528
  ds_read_b128 v[156:159], v30 offset:23552
  s_waitcnt lgkmcnt(0)
  s_call_b64 s[60:61], L_proc_S2_Y
  s_waitcnt vmcnt(4)
  s_add_u32 s69, s51, 229376
  s_add_u32 m0, s70, 16384
  s_nop 0
  buffer_load_dwordx4 v1, s[28:31], s69 offen offset:0 nt lds
  buffer_load_dwordx4 v1, s[28:31], s69 offen offset:1024 nt lds
  buffer_load_dwordx4 v1, s[28:31], s69 offen offset:2048 nt lds
  buffer_load_dwordx4 v1, s[28:31], s69 offen offset:3072 nt lds
  s_add_u32 m0, s70, 20480
  s_nop 0
  buffer_load_dwordx4 v2, s[32:35], s69 offen offset:0 nt lds
  buffer_load_dwordx4 v2, s[32:35], s69 offen offset:1024 nt lds
  buffer_load_dwordx4 v2, s[32:35], s69 offen offset:2048 nt lds
  buffer_load_dwordx4 v2, s[32:35], s69 offen offset:3072 nt lds
  s_waitcnt vmcnt(4)
  s_add_u32 s69, s51, 802816
  buffer_load_dwordx4 v[128:131], v1, s[28:31], s69 offen offset:0 nt
  buffer_load_dwordx4 v[132:135], v1, s[28:31], s69 offen offset:1024 nt
  buffer_load_dwordx4 v[136:139], v1, s[28:31], s69 offen offset:2048 nt
  buffer_load_dwordx4 v[140:143], v1, s[28:31], s69 offen offset:3072 nt
  buffer_load_dwordx4 v[144:147], v2, s[32:35], s69 offen offset:0 nt
  buffer_load_dwordx4 v[148:151], v2, s[32:35], s69 offen offset:1024 nt
  buffer_load_dwordx4 v[152:155], v2, s[32:35], s69 offen offset:2048 nt
  buffer_load_dwordx4 v[156:159], v2, s[32:35], s69 offen offset:3072 nt
  s_call_b64 s[60:61], L_proc_S1_X
  s_call_b64 s[60:61], L_proc_S3_Y
  v_add_u32 v30, s70, v2
  ds_read_b128 v[160:163], v30 offset:24576
  ds_read_b128 v[164:167], v30 offset:25600
  ds_read_b128 v[168:171], v30 offset:26624
  ds_read_b128 v[172:175], v30 offset:27648
  ds_read_b128 v[176:179], v30 offset:28672
  ds_read_b128 v[180:183], v30 offset:29696
  ds_read_b128 v[184:187], v30 offset:30720
  ds_read_b128 v[188:191], v30 offset:31744
  s_waitcnt lgkmcnt(0)
  s_call_b64 s[60:61], L_proc_S3_Y
  s_waitcnt vmcnt(4)
  s_add_u32 s69, s51, 344064
  s_add_u32 m0, s70, 24576
  s_nop 0
  buffer_load_dwordx4 v1, s[28:31], s69 offen offset:0 nt lds
  buffer_load_dwordx4 v1, s[28:31], s69 offen offset:1024 nt lds
  buffer_load_dwordx4 v1, s[28:31], s69 offen offset:2048 nt lds
  buffer_load_dwordx4 v1, s[28:31], s69 offen offset:3072 nt lds
  s_add_u32 m0, s70, 28672
  s_nop 0
  buffer_load_dwordx4 v2, s[32:35], s69 offen offset:0 nt lds
  buffer_load_dwordx4 v2, s[32:35], s69 offen offset:1024 nt lds
  buffer_load_dwordx4 v2, s[32:35], s69 offen offset:2048 nt lds
  buffer_load_dwordx4 v2, s[32:35], s69 offen offset:3072 nt lds
  s_waitcnt vmcnt(4)
  s_add_u32 s69, s51, 917504
  buffer_load_dwordx4 v[160:163], v1, s[28:31], s69 offen offset:0 nt
  buffer_load_dwordx4 v[164:167], v1, s[28:31], s69 offen offset:1024 nt
  buffer_load_dwordx4 v[168:171], v1, s[28:31], s69 offen offset:2048 nt
  buffer_load_dwordx4 v[172:175], v1, s[28:31], s69 offen offset:3072 nt
  buffer_load_dwordx4 v[176:179], v2, s[32:35], s69 offen offset:0 nt
  buffer_load_dwordx4 v[180:183], v2, s[32:35], s69 offen offset:1024 nt
  buffer_load_dwordx4 v[184:187], v2, s[32:35], s69 offen offset:2048 nt
  buffer_load_dwordx4 v[188:191], v2, s[32:35], s69 offen offset:3072 nt
  s_call_b64 s[60:61], L_proc_S2_X
  s_call_b64 s[60:61], L_proc_S4_Y
  v_add_u32 v30, s70, v2
  ds_read_b128 v[192:195], v30 offset:32768
  ds_read_b128 v[196:199], v30 offset:33792
  ds_read_b128 v[200:203], v30 offset:34816
  ds_read_b128 v[204:207], v30 offset:35840
  ds_read_b128 v[208:211], v30 offset:36864
  ds_read_b128 v[212:215], v30 offset:37888
  ds_read_b128 v[216:219], v30 offset:38912
  ds_read_b128 v[220:223], v30 offset:39936
  s_waitcnt lgkmcnt(0)
  s_call_b64 s[60:61], L_proc_S4_Y
  s_waitcnt vmcnt(4)
  s_add_u32 s69, s51, 458752
  s_add_u32 m0, s70, 32768
  s_nop 0
  buffer_load_dwordx4 v1, s[28:31], s69 offen offset:0 nt lds
  buffer_load_dwordx4 v1, s[28:31], s69 offen offset:1024 nt lds
  buffer_load_dwordx4 v1, s[28:31], s69 offen offset:2048 nt lds
  buffer_load_dwordx4 v1, s[28:31], s69 offen offset:3072 nt lds
  s_add_u32 m0, s70, 36864
  s_nop 0
  buffer_load_dwordx4 v2, s[32:35], s69 offen offset:0 nt lds
  buffer_load_dwordx4 v2, s[32:35], s69 offen offset:1024 nt lds
  buffer_load_dwordx4 v2, s[32:35], s69 offen offset:2048 nt lds
  buffer_load_dwordx4 v2, s[32:35], s69 offen offset:3072 nt lds
  s_waitcnt vmcnt(4)
  s_add_u32 s69, s51, 1032192
  buffer_load_dwordx4 v[192:195], v1, s[28:31], s69 offen offset:0 nt
  buffer_load_dwordx4 v[196:199], v1, s[28:31], s69 offen offset:1024 nt
  buffer_load_dwordx4 v[200:203], v1, s[28:31], s69 offen offset:2048 nt
  buffer_load_dwordx4 v[204:207], v1, s[28:31], s69 offen offset:3072 nt
  buffer_load_dwordx4 v[208:211], v2, s[32:35], s69 offen offset:0 nt
  buffer_load_dwordx4 v[212:215], v2, s[32:35], s69 offen offset:1024 nt
  buffer_load_dwordx4 v[216:219], v2, s[32:35], s69 offen offset:2048 nt
  buffer_load_dwordx4 v[220:223], v2, s[32:35], s69 offen offset:3072 nt
  s_call_b64 s[60:61], L_proc_S3_X
  s_call_b64 s[60:61], L_proc_S5_Y
  v_add_u32 v30, s70, v2
  ds_read_b128 v[224:227], v30 offset:0
  ds_read_b128 v[228:231], v30 offset:1024
  ds_read_b128 v[232:235], v30 offset:2048
  ds_read_b128 v[236:239], v30 offset:3072
  ds_read_b128 v[240:243], v30 offset:4096
  ds_read_b128 v[244:247], v30 offset:5120
  ds_read_b128 v[248:251], v30 offset:6144
  ds_read_b128 v[252:255], v30 offset:7168
  s_waitcnt lgkmcnt(0)
  s_call_b64 s[60:61], L_proc_S5_X
  s_waitcnt vmcnt(4)
  s_add_u32 s69, s51, 1146880
  buffer_load_dwordx4 v[224:227], v1, s[28:31], s69 offen offset:0 nt
  buffer_load_dwordx4 v[228:231], v1, s[28:31], s69 offen offset:1024 nt
  buffer_load_dwordx4 v[232:235], v1, s[28:31], s69 offen offset:2048 nt
  buffer_load_dwordx4 v[236:239], v1, s[28:31], s69 offen offset:3072 nt
  buffer_load_dwordx4 v[240:243], v2, s[32:35], s69 offen offset:0 nt
  buffer_load_dwordx4 v[244:247], v2, s[32:35], s69 offen offset:1024 nt
  buffer_load_dwordx4 v[248:251], v2, s[32:35], s69 offen offset:2048 nt
  buffer_load_dwordx4 v[252:255], v2, s[32:35], s69 offen offset:3072 nt
  s_waitcnt vmcnt(8)
  s_call_b64 s[60:61], L_proc_S4_X
  s_call_b64 s[60:61], L_proc_S6_Y
  v_add_u32 v30, s70, v2
  ds_read_b128 a[0:3], v30 offset:8192
  ds_read_b128 a[4:7], v30 offset:9216
  ds_read_b128 a[8:11], v30 offset:10240
  ds_read_b128 a[12:15], v30 offset:11264
  ds_read_b128 a[16:19], v30 offset:12288
  ds_read_b128 a[20:23], v30 offset:13312
  ds_read_b128 a[24:27], v30 offset:14336
  ds_read_b128 a[28:31], v30 offset:15360
  s_waitcnt lgkmcnt(0)
  s_call_b64 s[60:61], L_proc_S6_X
  s_waitcnt vmcnt(4)
  s_add_u32 s69, s51, 1261568
  buffer_load_dwordx4 a[0:3], v1, s[28:31], s69 offen offset:0 nt
  buffer_load_dwordx4 a[4:7], v1, s[28:31], s69 offen offset:1024 nt
  buffer_load_dwordx4 a[8:11], v1, s[28:31], s69 offen offset:2048 nt
  buffer_load_dwordx4 a[12:15], v1, s[28:31], s69 offen offset:3072 nt
  buffer_load_dwordx4 a[16:19], v2, s[32:35], s69 offen offset:0 nt
  buffer_load_dwordx4 a[20:23], v2, s[32:35], s69 offen offset:1024 nt
  buffer_load_dwordx4 a[24:27], v2, s[32:35], s69 offen offset:2048 nt
  buffer_load_dwordx4 a[28:31], v2, s[32:35], s69 offen offset:3072 nt
  s_waitcnt vmcnt(8)
  s_call_b64 s[60:61], L_proc_S5_X
  s_call_b64 s[60:61], L_proc_S7_Y
  v_add_u32 v30, s70, v2
  ds_read_b128 a[32:35], v30 offset:16384
  ds_read_b128 a[36:39], v30 offset:17408
  ds_read_b128 a[40:43], v30 offset:18432
  ds_read_b128 a[44:47], v30 offset:19456
  ds_read_b128 a[48:51], v30 offset:20480
  ds_read_b128 a[52:55], v30 offset:21504
  ds_read_b128 a[56:59], v30 offset:22528
  ds_read_b128 a[60:63], v30 offset:23552
  s_waitcnt lgkmcnt(0)
  s_call_b64 s[60:61], L_proc_S7_X
  s_waitcnt vmcnt(4)
  s_add_u32 s69, s51, 1376256
  buffer_load_dwordx4 a[32:35], v1, s[28:31], s69 offen offset:0 nt
  buffer_load_dwordx4 a[36:39], v1, s[28:31], s69 offen offset:1024 nt
  buffer_load_dwordx4 a[40:43], v1, s[28:31], s69 offen offset:2048 nt
  buffer_load_dwordx4 a[44:47], v1, s[28:31], s69 offen offset:3072 nt
  buffer_load_dwordx4 a[48:51], v2, s[32:35], s69 offen offset:0 nt
  buffer_load_dwordx4 a[52:55], v2, s[32:35], s69 offen offset:1024 nt
  buffer_load_dwordx4 a[56:59], v2, s[32:35], s69 offen offset:2048 nt
  buffer_load_dwordx4 a[60:63], v2, s[32:35], s69 offen offset:3072 nt
  s_waitcnt vmcnt(8)
  s_call_b64 s[60:61], L_proc_S6_X
  s_call_b64 s[60:61], L_proc_S8_Y
  v_add_u32 v30, s70, v2
  ds_read_b128 a[64:67], v30 offset:24576
  ds_read_b128 a[68:71], v30 offset:25600
  ds_read_b128 a[72:75], v30 offset:26624
  ds_read_b128 a[76:79], v30 offset:27648
  ds_read_b128 a[80:83], v30 offset:28672
  ds_read_b128 a[84:87], v30 offset:29696
  ds_read_b128 a[88:91], v30 offset:30720
  ds_read_b128 a[92:95], v30 offset:31744
  s_waitcnt lgkmcnt(0)
  s_call_b64 s[60:61], L_proc_S8_X
  s_waitcnt vmcnt(4)
  s_add_u32 s69, s51, 1490944
  buffer_load_dwordx4 a[64:67], v1, s[28:31], s69 offen offset:0 nt
  buffer_load_dwordx4 a[68:71], v1, s[28:31], s69 offen offset:1024 nt
  buffer_load_dwordx4 a[72:75], v1, s[28:31], s69 offen offset:2048 nt
  buffer_load_dwordx4 a[76:79], v1, s[28:31], s69 offen offset:3072 nt
  buffer_load_dwordx4 a[80:83], v2, s[32:35], s69 offen offset:0 nt
  buffer_load_dwordx4 a[84:87], v2, s[32:35], s69 offen offset:1024 nt
  buffer_load_dwordx4 a[88:91], v2, s[32:35], s69 offen offset:2048 nt
  buffer_load_dwordx4 a[92:95], v2, s[32:35], s69 offen offset:3072 nt
  s_waitcnt vmcnt(8)
  s_call_b64 s[60:61], L_proc_S7_X
  s_call_b64 s[60:61], L_proc_S9_Y
  v_add_u32 v30, s70, v2
  ds_read_b128 a[96:99], v30 offset:32768
  ds_read_b128 a[100:103], v30 offset:33792
  ds_read_b128 a[104:107], v30 offset:34816
  ds_read_b128 a[108:111], v30 offset:35840
  ds_read_b128 a[112:115], v30 offset:36864
  ds_read_b128 a[116:119], v30 offset:37888
  ds_read_b128 a[120:123], v30 offset:38912
  ds_read_b128 a[124:127], v30 offset:39936
  s_waitcnt lgkmcnt(0)
  s_call_b64 s[60:61], L_proc_S9_X
  s_waitcnt vmcnt(4)
  s_add_u32 s69, s51, 1605632
  buffer_load_dwordx4 a[96:99], v1, s[28:31], s69 offen offset:0 nt
  buffer_load_dwordx4 a[100:103], v1, s[28:31], s69 offen offset:1024 nt
  buffer_load_dwordx4 a[104:107], v1, s[28:31], s69 offen offset:2048 nt
  buffer_load_dwordx4 a[108:111], v1, s[28:31], s69 offen offset:3072 nt
  buffer_load_dwordx4 a[112:115], v2, s[32:35], s69 offen offset:0 nt
  buffer_load_dwordx4 a[116:119], v2, s[32:35], s69 offen offset:1024 nt
  buffer_load_dwordx4 a[120:123], v2, s[32:35], s69 offen offset:2048 nt
  buffer_load_dwordx4 a[124:127], v2, s[32:35], s69 offen offset:3072 nt
  s_waitcnt vmcnt(8)
  s_call_b64 s[60:61], L_proc_S8_X
  s_call_b64 s[60:61], L_proc_S10_Y
  s_waitcnt vmcnt(4)
  s_add_u32 s69, s51, 1720320
  buffer_load_dwordx4 a[128:131], v1, s[28:31], s69 offen offset:0 nt
  buffer_load_dwordx4 a[132:135], v1, s[28:31], s69 offen offset:1024 nt
  buffer_load_dwordx4 a[136:139], v1, s[28:31], s69 offen offset:2048 nt
  buffer_load_dwordx4 a[140:143], v1, s[28:31], s69 offen offset:3072 nt
  buffer_load_dwordx4 a[144:147], v2, s[32:35], s69 offen offset:0 nt
  buffer_load_dwordx4 a[148:151], v2, s[32:35], s69 offen offset:1024 nt
  buffer_load_dwordx4 a[152:155], v2, s[32:35], s69 offen offset:2048 nt
  buffer_load_dwordx4 a[156:159], v2, s[32:35], s69 offen offset:3072 nt
  s_waitcnt vmcnt(8)
  s_call_b64 s[60:61], L_proc_S9_X
  s_call_b64 s[60:61], L_proc_S11_Y
  s_waitcnt vmcnt(4)
  s_add_u32 s69, s51, 1835008
  buffer_load_dwordx4 a[160:163], v1, s[28:31], s69 offen offset:0 nt
  buffer_load_dwordx4 a[164:167], v1, s[28:31], s69 offen offset:1024 nt
  buffer_load_dwordx4 a[168:171], v1, s[28:31], s69 offen offset:2048 nt
  buffer_load_dwordx4 a[172:175], v1, s[28:31], s69 offen offset:3072 nt
  buffer_load_dwordx4 a[176:179], v2, s[32:35], s69 offen offset:0 nt
  buffer_load_dwordx4 a[180:183], v2, s[32:35], s69 offen offset:1024 nt
  buffer_load_dwordx4 a[184:187], v2, s[32:35], s69 offen offset:2048 nt
  buffer_load_dwordx4 a[188:191], v2, s[32:35], s69 offen offset:3072 nt
  s_waitcnt vmcnt(8)
  s_call_b64 s[60:61], L_proc_S10_X
  s_call_b64 s[60:61], L_proc_S12_Y
  s_waitcnt vmcnt(4)
  s_add_u32 s69, s51, 1949696
  buffer_load_dwordx4 a[192:195], v1, s[28:31], s69 offen offset:0 nt
  buffer_load_dwordx4 a[196:199], v1, s[28:31], s69 offen offset:1024 nt
  buffer_load_dwordx4 a[200:203], v1, s[28:31], s69 offen offset:2048 nt
  buffer_load_dwordx4 a[204:207], v1, s[28:31], s69 offen offset:3072 nt
  buffer_load_dwordx4 a[208:211], v2, s[32:35], s69 offen offset:0 nt
  buffer_load_dwordx4 a[212:215], v2, s[32:35], s69 offen offset:1024 nt
  buffer_load_dwordx4 a[216:219], v2, s[32:35], s69 offen offset:2048 nt
  buffer_load_dwordx4 a[220:223], v2, s[32:35], s69 offen offset:3072 nt
  s_waitcnt vmcnt(8)
  s_call_b64 s[60:61], L_proc_S11_X
  s_call_b64 s[60:61], L_proc_S13_Y
  s_waitcnt vmcnt(4)
  s_add_u32 s69, s51, 2064384
  buffer_load_dwordx4 a[224:227], v1, s[28:31], s69 offen offset:0 nt
  buffer_load_dwordx4 a[228:231], v1, s[28:31], s69 offen offset:1024 nt
  buffer_load_dwordx4 a[232:235], v1, s[28:31], s69 offen offset:2048 nt
  buffer_load_dwordx4 a[236:239], v1, s[28:31], s69 offen offset:3072 nt
  buffer_load_dwordx4 a[240:243], v2, s[32:35], s69 offen offset:0 nt
  buffer_load_dwordx4 a[244:247], v2, s[32:35], s69 offen offset:1024 nt
  buffer_load_dwordx4 a[248:251], v2, s[32:35], s69 offen offset:2048 nt
  buffer_load_dwordx4 a[252:255], v2, s[32:35], s69 offen offset:3072 nt
  s_waitcnt vmcnt(8)
  s_call_b64 s[60:61], L_proc_S12_X
  s_waitcnt vmcnt(0)
  s_call_b64 s[60:61], L_proc_S13_X
  s_nop 7
  v_mov_b32 v30, v12
  s_nop 1
  v_add_f32_dpp v30, v30, v30 row_ror:4 row_mask:0xf bank_mask:0xf
  s_nop 1
  v_add_f32_dpp v30, v30, v30 row_ror:8 row_mask:0xf bank_mask:0xf
  s_nop 1
  v_add_f32_dpp v30, v30, v30 row_bcast:15 row_mask:0xa bank_mask:0xf
  s_nop 1
  v_add_f32_dpp v30, v30, v30 row_bcast:31 row_mask:0xc bank_mask:0xf
  s_nop 0
  v_readlane_b32 s66, v30, 63
  v_and_b32 v31, 0xf0, v2
  v_lshlrev_b32 v31, 1, v31
  v_lshrrev_b32 v22, 4, v2
  v_and_b32 v22, 0x10, v22
  v_add_u32 v31, v31, v22
  v_cmp_gt_u32 vcc, 512, v2
  s_nop 1
  v_cndmask_b32 v31, v2, v31, vcc
  v_writelane_b32 v8, s72, 32
  v_writelane_b32 v9, s66, 32
  s_mul_i32 s67, s44, 28
  s_add_u32 s67, s67, s45
  s_mul_i32 s67, s67, 640
  s_add_u32 s67, s67, 1163264
  s_mov_b32 exec_hi, 0xff
  buffer_store_dwordx4 v[8:11], v31, s[36:39], s67 offen sc0 sc1
  s_mov_b32 exec_hi, -1
  s_nop 1
  v_mov_b32 v4, v14
  v_mov_b32 v8, v18
  v_mov_b32 v5, v15
  v_mov_b32 v9, v19
  v_mov_b32 v6, v16
  v_mov_b32 v10, v20
  v_mov_b32 v7, v17
  v_mov_b32 v11, v21
  s_mov_b32 s72, s73
  v_mov_b32 v12, v13
  s_mov_b32 s71, 0
L_pool2:
  s_cmp_lg_u32 s47, 2
  s_cbranch_scc1 L_pool2_end
  s_call_b64 s[62:63], L_pair_step
  s_cmp_eq_u32 s71, 2
  s_cbranch_scc1 L_pool2
  s_cmp_eq_u32 s71, 0
  s_cbranch_scc1 L_pqi_25
  s_waitcnt vmcnt(9)
  v_max_u32 v30, v14, v15
  v_max3_u32 v30, v30, v16, v17
  v_cmp_eq_u32 vcc, -1, v30
  s_nop 4
  s_cbranch_vccnz L_pqi_25
  s_mov_b32 s71, 2
  s_branch L_pool2
L_pqi_25:
  s_lshl_b32 s67, s44, 8
  s_add_u32 s67, s67, 32768
  v_and_b32 v30, 0xff, v1
  buffer_load_dwordx4 v[14:17], v30, s[36:39], s67 offen sc1
  s_mov_b32 s71, 1
  s_branch L_pool2
L_pool2_end:
  s_cmp_eq_u32 s71, 2
  s_cbranch_scc1 L_pqd_26
  s_lshl_b32 s67, s44, 8
  s_add_u32 s67, s67, 32768
  v_and_b32 v30, 0xff, v1
  buffer_load_dwordx4 v[14:17], v30, s[36:39], s67 offen sc1
  s_waitcnt vmcnt(0)
  s_mov_b32 s98, 0
L_qpoll_27:
  v_max_u32 v30, v14, v15
  v_max3_u32 v30, v30, v16, v17
  v_cmp_eq_u32 vcc, -1, v30
  s_nop 4
  s_cbranch_vccz L_qdone_28
  s_add_u32 s98, s98, 1
  s_cmp_gt_u32 s98, 400000
  s_cbranch_scc1 L_qdone_28_to
  s_cmp_lg_u32 s99, 0
  s_cbranch_scc1 L_qdone_28
  s_sleep 4
  s_lshl_b32 s67, s44, 8
  s_add_u32 s67, s67, 32768
  v_and_b32 v30, 0xff, v1
  buffer_load_dwordx4 v[14:17], v30, s[36:39], s67 offen sc1
  s_waitcnt vmcnt(0)
  s_branch L_qpoll_27
L_qdone_28_to:
  s_mov_b32 s99, 1
L_qdone_28:
L_pqd_26:
  s_nop 7
  v_mov_b32 v30, v12
  s_nop 1
  v_add_f32_dpp v30, v30, v30 row_ror:4 row_mask:0xf bank_mask:0xf
  s_nop 1
  v_add_f32_dpp v30, v30, v30 row_ror:8 row_mask:0xf bank_mask:0xf
  s_nop 1
  v_add_f32_dpp v30, v30, v30 row_bcast:15 row_mask:0xa bank_mask:0xf
  s_nop 1
  v_add_f32_dpp v30, v30, v30 row_bcast:31 row_mask:0xc bank_mask:0xf
  s_nop 0
  v_readlane_b32 s66, v30, 63
  v_and_b32 v31, 0xf0, v2
  v_lshlrev_b32 v31, 1, v31
  v_lshrrev_b32 v22, 4, v2
  v_and_b32 v22, 0x10, v22
  v_add_u32 v31, v31, v22
  v_cmp_gt_u32 vcc, 512, v2
  s_nop 1
  v_cndmask_b32 v31, v2, v31, vcc
  v_writelane_b32 v8, s72, 32
  v_writelane_b32 v9, s66, 32
  s_mul_i32 s67, s44, 28
  s_add_u32 s67, s67, s45
  s_mul_i32 s67, s67, 640
  s_add_u32 s67, s67, 1736704
  s_mov_b32 exec_hi, 0xff
  buffer_store_dwordx4 v[8:11], v31, s[36:39], s67 offen sc0 sc1
  s_mov_b32 exec_hi, -1
  s_nop 1
  v_mov_b32 v4, v14
  v_mov_b32 v5, v15
  v_mov_b32 v6, v16
  v_mov_b32 v7, v17
  v_mov_b32 v8, 0
  v_mov_b32 v9, 0
  v_mov_b32 v10, 0
  v_mov_b32 v11, 0
  s_mov_b32 s72, 0xf149f2ca
  v_mov_b32 v12, 0
  v_mov_b32 v18, 0
  v_mov_b32 v19, 0
  v_mov_b32 v20, 0
  v_mov_b32 v21, 0
  s_mov_b32 s73, 0xf149f2ca
  v_mov_b32 v13, 0
  s_cmp_lg_u32 s47, 3
  s_cbranch_scc1 L_pif_29
  s_call_b64 s[62:63], L_pair_step
L_pif_29:
  s_call_b64 s[60:61], L_proc_S0_Y
  s_call_b64 s[60:61], L_proc_S1_Y
  s_cmp_lg_u32 s47, 3
  s_cbranch_scc1 L_pif_30
  s_call_b64 s[62:63], L_pair_step
L_pif_30:
  s_call_b64 s[60:61], L_proc_S2_Y
  s_call_b64 s[60:61], L_proc_S3_Y
  s_cmp_lg_u32 s47, 3
  s_cbranch_scc1 L_pif_31
  s_call_b64 s[62:63], L_pair_step
L_pif_31:
  s_call_b64 s[60:61], L_proc_S4_Y
  s_call_b64 s[60:61], L_proc_S5_Y
  s_cmp_lg_u32 s47, 3
  s_cbranch_scc1 L_pif_32
  s_call_b64 s[62:63], L_pair_step
L_pif_32:
  s_call_b64 s[60:61], L_proc_S6_Y
  s_call_b64 s[60:61], L_proc_S7_Y
  s_cmp_lg_u32 s47, 3
  s_cbranch_scc1 L_pif_33
  s_call_b64 s[62:63], L_pair_step
L_pif_33:
  s_call_b64 s[60:61], L_proc_S8_Y
  s_call_b64 s[60:61], L_proc_S9_Y
  s_cmp_lg_u32 s47, 3
  s_cbranch_scc1 L_pif_34
  s_call_b64 s[62:63], L_pair_step
L_pif_34:
  s_call_b64 s[60:61], L_proc_S10_Y
  s_call_b64 s[60:61], L_proc_S11_Y
  s_cmp_lg_u32 s47, 3
  s_cbranch_scc1 L_pif_35
  s_call_b64 s[62:63], L_pair_step
L_pif_35:
  s_call_b64 s[60:61], L_proc_S12_Y
  s_call_b64 s[60:61], L_proc_S13_Y
  s_cmp_lg_u32 s47, 3
  s_cbranch_scc1 L_pif_36
  s_call_b64 s[62:63], L_pair_step
L_pif_36:
  v_add_u32 v30, s70, v2
  ds_read_b128 v[64:67], v30 offset:0
  ds_read_b128 v[68:71], v30 offset:1024
  ds_read_b128 v[72:75], v30 offset:2048
  ds_read_b128 v[76:79], v30 offset:3072
  ds_read_b128 v[80:83], v30 offset:4096
  ds_read_b128 v[84:87], v30 offset:5120
  ds_read_b128 v[88:91], v30 offset:6144
  ds_read_b128 v[92:95], v30 offset:7168
  s_waitcnt lgkmcnt(0)
  s_call_b64 s[60:61], L_proc_S0_Y
  v_add_u32 v30, s70, v2
  ds_read_b128 v[64:67], v30 offset:8192
  ds_read_b128 v[68:71], v30 offset:9216
  ds_read_b128 v[72:75], v30 offset:10240
  ds_read_b128 v[76:79], v30 offset:11264
  ds_read_b128 v[80:83], v30 offset:12288
  ds_read_b128 v[84:87], v30 offset:13312
  ds_read_b128 v[88:91], v30 offset:14336
  ds_read_b128 v[92:95], v30 offset:15360
  s_waitcnt lgkmcnt(0)
  s_call_b64 s[60:61], L_proc_S0_Y
  s_cmp_lg_u32 s47, 3
  s_cbranch_scc1 L_pif_37
  s_call_b64 s[62:63], L_pair_step
L_pif_37:
  v_add_u32 v30, s70, v2
  ds_read_b128 v[64:67], v30 offset:16384
  ds_read_b128 v[68:71], v30 offset:17408
  ds_read_b128 v[72:75], v30 offset:18432
  ds_read_b128 v[76:79], v30 offset:19456
  ds_read_b128 v[80:83], v30 offset:20480
  ds_read_b128 v[84:87], v30 offset:21504
  ds_read_b128 v[88:91], v30 offset:22528
  ds_read_b128 v[92:95], v30 offset:23552
  s_waitcnt lgkmcnt(0)
  s_call_b64 s[60:61], L_proc_S0_Y
  v_add_u32 v30, s70, v2
  ds_read_b128 v[64:67], v30 offset:24576
  ds_read_b128 v[68:71], v30 offset:25600
  ds_read_b128 v[72:75], v30 offset:26624
  ds_read_b128 v[76:79], v30 offset:27648
  ds_read_b128 v[80:83], v30 offset:28672
  ds_read_b128 v[84:87], v30 offset:29696
  ds_read_b128 v[88:91], v30 offset:30720
  ds_read_b128 v[92:95], v30 offset:31744
  s_waitcnt lgkmcnt(0)
  s_call_b64 s[60:61], L_proc_S0_Y
  s_cmp_lg_u32 s47, 3
  s_cbranch_scc1 L_pif_38
  s_call_b64 s[62:63], L_pair_step
L_pif_38:
  v_add_u32 v30, s70, v2
  ds_read_b128 v[64:67], v30 offset:32768
  ds_read_b128 v[68:71], v30 offset:33792
  ds_read_b128 v[72:75], v30 offset:34816
  ds_read_b128 v[76:79], v30 offset:35840
  ds_read_b128 v[80:83], v30 offset:36864
  ds_read_b128 v[84:87], v30 offset:37888
  ds_read_b128 v[88:91], v30 offset:38912
  ds_read_b128 v[92:95], v30 offset:39936
  s_waitcnt lgkmcnt(0)
  s_call_b64 s[60:61], L_proc_S0_Y
  s_nop 7
  v_mov_b32 v30, s72
  v_mov_b32 v22, s73
  v_max_f32 v31, v30, v22
  v_sub_f32 v30, v30, v31
  v_sub_f32 v22, v22, v31
  v_exp_f32 v30, v30
  v_exp_f32 v22, v22
  v_readfirstlane_b32 s72, v31
  v_mul_f32 v8, v30, v8
  v_fmac_f32 v8, v22, v18
  v_mul_f32 v9, v30, v9
  v_fmac_f32 v9, v22, v19
  v_mul_f32 v10, v30, v10
  v_fmac_f32 v10, v22, v20
  v_mul_f32 v11, v30, v11
  v_fmac_f32 v11, v22, v21
  v_mul_f32 v12, v30, v12
  v_fmac_f32 v12, v22, v13
L_pool3:
  s_cmp_lg_u32 s47, 3
  s_cbranch_scc1 L_pool3_end
  s_call_b64 s[62:63], L_pair_step
  s_branch L_pool3
L_pool3_end:
  s_nop 7
  v_mov_b32 v30, v12
  s_nop 1
  v_add_f32_dpp v30, v30, v30 row_ror:4 row_mask:0xf bank_mask:0xf
  s_nop 1
  v_add_f32_dpp v30, v30, v30 row_ror:8 row_mask:0xf bank_mask:0xf
  s_nop 1
  v_add_f32_dpp v30, v30, v30 row_bcast:15 row_mask:0xa bank_mask:0xf
  s_nop 1
  v_add_f32_dpp v30, v30, v30 row_bcast:31 row_mask:0xc bank_mask:0xf
  s_nop 0
  v_readlane_b32 s66, v30, 63
  v_and_b32 v31, 0xf0, v2
  v_lshlrev_b32 v31, 1, v31
  v_lshrrev_b32 v22, 4, v2
  v_and_b32 v22, 0x10, v22
  v_add_u32 v31, v31, v22
  v_cmp_gt_u32 vcc, 512, v2
  s_nop 1
  v_cndmask_b32 v31, v2, v31, vcc
  v_writelane_b32 v8, s72, 32
  v_writelane_b32 v9, s66, 32
  s_mul_i32 s67, s44, 28
  s_add_u32 s67, s67, s45
  s_mul_i32 s67, s67, 640
  s_add_u32 s67, s67, 2310144
  s_mov_b32 exec_hi, 0xff
  buffer_store_dwordx4 v[8:11], v31, s[36:39], s67 offen sc0 sc1
  s_mov_b32 exec_hi, -1
  s_nop 1
  s_endpgm
L_pair_step:
  s_waitcnt vmcnt(4)
  v_readfirstlane_b32 s50, v0
  s_nop 3
  s_mov_b32 s49, 0
  s_mov_b32 s67, s50
  s_cmp_lt_u32 s67, 492
  s_cbranch_scc1 L_decd_39
  s_sub_u32 s67, s67, 492
  s_add_u32 s49, s49, 1
  s_cmp_lt_u32 s67, 492
  s_cbranch_scc1 L_decd_39
  s_sub_u32 s67, s67, 492
  s_add_u32 s49, s49, 1
  s_cmp_lt_u32 s67, 492
  s_cbranch_scc1 L_decd_39
  s_sub_u32 s67, s67, 492
  s_add_u32 s49, s49, 1
  s_cmp_lt_u32 s67, 492
  s_cbranch_scc1 L_decd_39
  s_sub_u32 s67, s67, 492
  s_add_u32 s49, s49, 1
L_decd_39:
  s_mov_b32 s83, 0x10000000
  s_lshl_b32 s48, s67, 12
  s_add_u32 s48, s48, 2179072
  s_add_u32 s48, s48, s46
  s_and_b32 s68, s49, 1
  s_xor_b32 s68, s68, 1
  s_lshl_b32 s68, s68, 27
  s_add_u32 s48, s48, s68
  s_cmp_ge_u32 s49, 4
  s_cselect_b32 s48, 0x10000000, s48
  v_mov_b32 v0, 1
  s_lshl_b32 s67, s44, 8
  v_mov_b32 v30, 0
  s_mov_b64 exec, 1
  buffer_atomic_add v0, v30, s[36:39], s67 offen sc0 sc1
  s_mov_b64 exec, -1
  v_cndmask_b32_e64 v26, 0, v4, s[52:53]
  v_cndmask_b32_e64 v27, 0, v5, s[52:53]
  v_cndmask_b32_e64 v28, 0, v6, s[52:53]
  v_cndmask_b32_e64 v29, 0, v7, s[52:53]
  v_mov_b32 v31, s72
  s_nop 0
  v_mfma_f32_16x16x32_bf16 v[22:25], v[32:35], v[26:29], 0
  v_cndmask_b32_e64 v26, 0, v4, s[54:55]
  v_cndmask_b32_e64 v27, 0, v5, s[54:55]
  v_cndmask_b32_e64 v28, 0, v6, s[54:55]
  v_cndmask_b32_e64 v29, 0, v7, s[54:55]
  s_nop 1
  v_mfma_f32_16x16x32_bf16 v[22:25], v[36:39], v[26:29], v[22:25]
  v_cndmask_b32_e64 v26, 0, v4, s[56:57]
  v_cndmask_b32_e64 v27, 0, v5, s[56:57]
  v_cndmask_b32_e64 v28, 0, v6, s[56:57]
  v_cndmask_b32_e64 v29, 0, v7, s[56:57]
  s_nop 1
  v_mfma_f32_16x16x32_bf16 v[22:25], v[40:43], v[26:29], v[22:25]
  v_cndmask_b32_e64 v26, 0, v4, s[58:59]
  v_cndmask_b32_e64 v27, 0, v5, s[58:59]
  v_cndmask_b32_e64 v28, 0, v6, s[58:59]
  v_cndmask_b32_e64 v29, 0, v7, s[58:59]
  s_nop 1
  v_mfma_f32_16x16x32_bf16 v[22:25], v[44:47], v[26:29], v[22:25]
  buffer_load_dwordx4 v[32:35], v1, s[28:31], s48 offen offset:0 nt
  buffer_load_dwordx4 v[36:39], v1, s[28:31], s48 offen offset:1024 nt
  buffer_load_dwordx4 v[40:43], v1, s[28:31], s48 offen offset:2048 nt
  buffer_load_dwordx4 v[44:47], v1, s[28:31], s48 offen offset:3072 nt
  s_nop 3
  v_mov_b32_dpp v30, v22 quad_perm:[0,0,0,0] row_mask:0xf bank_mask:0xf
  v_add_f32_dpp v30, v23, v30 quad_perm:[1,1,1,1] row_mask:0xf bank_mask:0xf
  v_add_f32_dpp v30, v24, v30 quad_perm:[2,2,2,2] row_mask:0xf bank_mask:0xf
  v_add_f32_dpp v30, v25, v30 quad_perm:[3,3,3,3] row_mask:0xf bank_mask:0xf
  v_mul_f32 v30, s64, v30
  v_max_f32 v23, v30, v31
  s_nop 1
  v_max_f32_dpp v23, v23, v23 row_ror:4 row_mask:0xf bank_mask:0xf
  s_nop 1
  v_max_f32_dpp v23, v23, v23 row_ror:8 row_mask:0xf bank_mask:0xf
  s_nop 1
  v_max_f32_dpp v23, v23, v23 row_bcast:15 row_mask:0xa bank_mask:0xf
  s_nop 1
  v_max_f32_dpp v23, v23, v23 row_bcast:31 row_mask:0xc bank_mask:0xf
  s_nop 0
  v_readlane_b32 s65, v23, 63
  s_nop 1
  v_subrev_f32 v22, s65, v30
  v_subrev_f32 v23, s65, v31
  v_exp_f32 v22, v22
  v_exp_f32 v23, v23
  s_mov_b32 s72, s65
  s_nop 0
  v_cvt_pk_bf16_f32 v24, v22, v22
  v_mul_f32 v8, v23, v8
  v_mul_f32 v9, v23, v9
  v_mul_f32 v10, v23, v10
  v_mul_f32 v11, v23, v11
  v_fma_f32 v12, v12, v23, v22
  s_waitcnt vmcnt(5)
  v_and_b32_dpp v25, v24, v3 row_newbcast:0 row_mask:0xf bank_mask:0xf
  v_cndmask_b32_e64 v26, 0, v25, s[74:75]
  v_cndmask_b32_e64 v27, 0, v25, s[76:77]
  v_cndmask_b32_e64 v28, 0, v25, s[78:79]
  v_cndmask_b32_e64 v29, 0, v25, s[80:81]
  s_nop 1
  v_mfma_f32_16x16x32_bf16 v[8:11], v[26:29], v[48:51], v[8:11]
  v_and_b32_dpp v25, v24, v3 row_newbcast:4 row_mask:0xf bank_mask:0xf
  v_cndmask_b32_e64 v26, 0, v25, s[74:75]
  v_cndmask_b32_e64 v27, 0, v25, s[76:77]
  v_cndmask_b32_e64 v28, 0, v25, s[78:79]
  v_cndmask_b32_e64 v29, 0, v25, s[80:81]
  s_nop 1
  v_mfma_f32_16x16x32_bf16 v[8:11], v[26:29], v[52:55], v[8:11]
  v_and_b32_dpp v25, v24, v3 row_newbcast:8 row_mask:0xf bank_mask:0xf
  v_cndmask_b32_e64 v26, 0, v25, s[74:75]
  v_cndmask_b32_e64 v27, 0, v25, s[76:77]
  v_cndmask_b32_e64 v28, 0, v25, s[78:79]
  v_cndmask_b32_e64 v29, 0, v25, s[80:81]
  s_nop 1
  v_mfma_f32_16x16x32_bf16 v[8:11], v[26:29], v[56:59], v[8:11]
  v_and_b32_dpp v25, v24, v3 row_newbcast:12 row_mask:0xf bank_mask:0xf
  v_cndmask_b32_e64 v26, 0, v25, s[74:75]
  v_cndmask_b32_e64 v27, 0, v25, s[76:77]
  v_cndmask_b32_e64 v28, 0, v25, s[78:79]
  v_cndmask_b32_e64 v29, 0, v25, s[80:81]
  s_nop 1
  v_mfma_f32_16x16x32_bf16 v[8:11], v[26:29], v[60:63], v[8:11]
  buffer_load_dwordx4 v[48:51], v2, s[32:35], s48 offen offset:0 nt
  buffer_load_dwordx4 v[52:55], v2, s[32:35], s48 offen offset:1024 nt
  buffer_load_dwordx4 v[56:59], v2, s[32:35], s48 offen offset:2048 nt
  buffer_load_dwordx4 v[60:63], v2, s[32:35], s48 offen offset:3072 nt
  s_mov_b32 s47, s49
  s_setpc_b64 s[62:63]
L_proc_F0_X:
  v_cndmask_b32_e64 v26, 0, v4, s[52:53]
  v_cndmask_b32_e64 v27, 0, v5, s[52:53]
  v_cndmask_b32_e64 v28, 0, v6, s[52:53]
  v_cndmask_b32_e64 v29, 0, v7, s[52:53]
  v_mov_b32 v31, s72
  s_nop 0
  v_mfma_f32_16x16x32_bf16 v[22:25], v[32:35], v[26:29], 0
  v_cndmask_b32_e64 v26, 0, v4, s[54:55]
  v_cndmask_b32_e64 v27, 0, v5, s[54:55]
  v_cndmask_b32_e64 v28, 0, v6, s[54:55]
  v_cndmask_b32_e64 v29, 0, v7, s[54:55]
  s_nop 1
  v_mfma_f32_16x16x32_bf16 v[22:25], v[36:39], v[26:29], v[22:25]
  v_cndmask_b32_e64 v26, 0, v4, s[56:57]
  v_cndmask_b32_e64 v27, 0, v5, s[56:57]
  v_cndmask_b32_e64 v28, 0, v6, s[56:57]
  v_cndmask_b32_e64 v29, 0, v7, s[56:57]
  s_nop 1
  v_mfma_f32_16x16x32_bf16 v[22:25], v[40:43], v[26:29], v[22:25]
  v_cndmask_b32_e64 v26, 0, v4, s[58:59]
  v_cndmask_b32_e64 v27, 0, v5, s[58:59]
  v_cndmask_b32_e64 v28, 0, v6, s[58:59]
  v_cndmask_b32_e64 v29, 0, v7, s[58:59]
  s_nop 1
  v_mfma_f32_16x16x32_bf16 v[22:25], v[44:47], v[26:29], v[22:25]
  s_nop 7
  v_mov_b32_dpp v30, v22 quad_perm:[0,0,0,0] row_mask:0xf bank_mask:0xf
  v_add_f32_dpp v30, v23, v30 quad_perm:[1,1,1,1] row_mask:0xf bank_mask:0xf
  v_add_f32_dpp v30, v24, v30 quad_perm:[2,2,2,2] row_mask:0xf bank_mask:0xf
  v_add_f32_dpp v30, v25, v30 quad_perm:[3,3,3,3] row_mask:0xf bank_mask:0xf
  v_mul_f32 v30, s64, v30
  v_max_f32 v23, v30, v31
  s_nop 1
  v_max_f32_dpp v23, v23, v23 row_ror:4 row_mask:0xf bank_mask:0xf
  s_nop 1
  v_max_f32_dpp v23, v23, v23 row_ror:8 row_mask:0xf bank_mask:0xf
  s_nop 1
  v_max_f32_dpp v23, v23, v23 row_bcast:15 row_mask:0xa bank_mask:0xf
  s_nop 1
  v_max_f32_dpp v23, v23, v23 row_bcast:31 row_mask:0xc bank_mask:0xf
  s_nop 0
  v_readlane_b32 s65, v23, 63
  s_nop 1
  v_subrev_f32 v22, s65, v30
  v_subrev_f32 v23, s65, v31
  v_exp_f32 v22, v22
  v_exp_f32 v23, v23
  s_mov_b32 s72, s65
  s_nop 0
  v_cvt_pk_bf16_f32 v24, v22, v22
  v_mul_f32 v8, v23, v8
  v_mul_f32 v9, v23, v9
  v_mul_f32 v10, v23, v10
  v_mul_f32 v11, v23, v11
  v_fma_f32 v12, v12, v23, v22
  v_and_b32_dpp v25, v24, v3 row_newbcast:0 row_mask:0xf bank_mask:0xf
  v_cndmask_b32_e64 v26, 0, v25, s[74:75]
  v_cndmask_b32_e64 v27, 0, v25, s[76:77]
  v_cndmask_b32_e64 v28, 0, v25, s[78:79]
  v_cndmask_b32_e64 v29, 0, v25, s[80:81]
  s_nop 1
  v_mfma_f32_16x16x32_bf16 v[8:11], v[26:29], v[48:51], v[8:11]
  v_and_b32_dpp v25, v24, v3 row_newbcast:4 row_mask:0xf bank_mask:0xf
  v_cndmask_b32_e64 v26, 0, v25, s[74:75]
  v_cndmask_b32_e64 v27, 0, v25, s[76:77]
  v_cndmask_b32_e64 v28, 0, v25, s[78:79]
  v_cndmask_b32_e64 v29, 0, v25, s[80:81]
  s_nop 1
  v_mfma_f32_16x16x32_bf16 v[8:11], v[26:29], v[52:55], v[8:11]
  v_and_b32_dpp v25, v24, v3 row_newbcast:8 row_mask:0xf bank_mask:0xf
  v_cndmask_b32_e64 v26, 0, v25, s[74:75]
  v_cndmask_b32_e64 v27, 0, v25, s[76:77]
  v_cndmask_b32_e64 v28, 0, v25, s[78:79]
  v_cndmask_b32_e64 v29, 0, v25, s[80:81]
  s_nop 1
  v_mfma_f32_16x16x32_bf16 v[8:11], v[26:29], v[56:59], v[8:11]
  v_and_b32_dpp v25, v24, v3 row_newbcast:12 row_mask:0xf bank_mask:0xf
  v_cndmask_b32_e64 v26, 0, v25, s[74:75]
  v_cndmask_b32_e64 v27, 0, v25, s[76:77]
  v_cndmask_b32_e64 v28, 0, v25, s[78:79]
  v_cndmask_b32_e64 v29, 0, v25, s[80:81]
  s_nop 1
  v_mfma_f32_16x16x32_bf16 v[8:11], v[26:29], v[60:63], v[8:11]
  s_setpc_b64 s[60:61]
L_proc_F0_Y:
  v_cndmask_b32_e64 v26, 0, v14, s[52:53]
  v_cndmask_b32_e64 v27, 0, v15, s[52:53]
  v_cndmask_b32_e64 v28, 0, v16, s[52:53]
  v_cndmask_b32_e64 v29, 0, v17, s[52:53]
  v_mov_b32 v31, s73
  s_nop 0
  v_mfma_f32_16x16x32_bf16 v[22:25], v[32:35], v[26:29], 0
  v_cndmask_b32_e64 v26, 0, v14, s[54:55]
  v_cndmask_b32_e64 v27, 0, v15, s[54:55]
  v_cndmask_b32_e64 v28, 0, v16, s[54:55]
  v_cndmask_b32_e64 v29, 0, v17, s[54:55]
  s_nop 1
  v_mfma_f32_16x16x32_bf16 v[22:25], v[36:39], v[26:29], v[22:25]
  v_cndmask_b32_e64 v26, 0, v14, s[56:57]
  v_cndmask_b32_e64 v27, 0, v15, s[56:57]
  v_cndmask_b32_e64 v28, 0, v16, s[56:57]
  v_cndmask_b32_e64 v29, 0, v17, s[56:57]
  s_nop 1
  v_mfma_f32_16x16x32_bf16 v[22:25], v[40:43], v[26:29], v[22:25]
  v_cndmask_b32_e64 v26, 0, v14, s[58:59]
  v_cndmask_b32_e64 v27, 0, v15, s[58:59]
  v_cndmask_b32_e64 v28, 0, v16, s[58:59]
  v_cndmask_b32_e64 v29, 0, v17, s[58:59]
  s_nop 1
  v_mfma_f32_16x16x32_bf16 v[22:25], v[44:47], v[26:29], v[22:25]
  s_nop 7
  v_mov_b32_dpp v30, v22 quad_perm:[0,0,0,0] row_mask:0xf bank_mask:0xf
  v_add_f32_dpp v30, v23, v30 quad_perm:[1,1,1,1] row_mask:0xf bank_mask:0xf
  v_add_f32_dpp v30, v24, v30 quad_perm:[2,2,2,2] row_mask:0xf bank_mask:0xf
  v_add_f32_dpp v30, v25, v30 quad_perm:[3,3,3,3] row_mask:0xf bank_mask:0xf
  v_mul_f32 v30, s64, v30
  v_max_f32 v23, v30, v31
  s_nop 1
  v_max_f32_dpp v23, v23, v23 row_ror:4 row_mask:0xf bank_mask:0xf
  s_nop 1
  v_max_f32_dpp v23, v23, v23 row_ror:8 row_mask:0xf bank_mask:0xf
  s_nop 1
  v_max_f32_dpp v23, v23, v23 row_bcast:15 row_mask:0xa bank_mask:0xf
  s_nop 1
  v_max_f32_dpp v23, v23, v23 row_bcast:31 row_mask:0xc bank_mask:0xf
  s_nop 0
  v_readlane_b32 s65, v23, 63
  s_nop 1
  v_subrev_f32 v22, s65, v30
  v_subrev_f32 v23, s65, v31
  v_exp_f32 v22, v22
  v_exp_f32 v23, v23
  s_mov_b32 s73, s65
  s_nop 0
  v_cvt_pk_bf16_f32 v24, v22, v22
  v_mul_f32 v18, v23, v18
  v_mul_f32 v19, v23, v19
  v_mul_f32 v20, v23, v20
  v_mul_f32 v21, v23, v21
  v_fma_f32 v13, v13, v23, v22
  v_and_b32_dpp v25, v24, v3 row_newbcast:0 row_mask:0xf bank_mask:0xf
  v_cndmask_b32_e64 v26, 0, v25, s[74:75]
  v_cndmask_b32_e64 v27, 0, v25, s[76:77]
  v_cndmask_b32_e64 v28, 0, v25, s[78:79]
  v_cndmask_b32_e64 v29, 0, v25, s[80:81]
  s_nop 1
  v_mfma_f32_16x16x32_bf16 v[18:21], v[26:29], v[48:51], v[18:21]
  v_and_b32_dpp v25, v24, v3 row_newbcast:4 row_mask:0xf bank_mask:0xf
  v_cndmask_b32_e64 v26, 0, v25, s[74:75]
  v_cndmask_b32_e64 v27, 0, v25, s[76:77]
  v_cndmask_b32_e64 v28, 0, v25, s[78:79]
  v_cndmask_b32_e64 v29, 0, v25, s[80:81]
  s_nop 1
  v_mfma_f32_16x16x32_bf16 v[18:21], v[26:29], v[52:55], v[18:21]
  v_and_b32_dpp v25, v24, v3 row_newbcast:8 row_mask:0xf bank_mask:0xf
  v_cndmask_b32_e64 v26, 0, v25, s[74:75]
  v_cndmask_b32_e64 v27, 0, v25, s[76:77]
  v_cndmask_b32_e64 v28, 0, v25, s[78:79]
  v_cndmask_b32_e64 v29, 0, v25, s[80:81]
  s_nop 1
  v_mfma_f32_16x16x32_bf16 v[18:21], v[26:29], v[56:59], v[18:21]
  v_and_b32_dpp v25, v24, v3 row_newbcast:12 row_mask:0xf bank_mask:0xf
  v_cndmask_b32_e64 v26, 0, v25, s[74:75]
  v_cndmask_b32_e64 v27, 0, v25, s[76:77]
  v_cndmask_b32_e64 v28, 0, v25, s[78:79]
  v_cndmask_b32_e64 v29, 0, v25, s[80:81]
  s_nop 1
  v_mfma_f32_16x16x32_bf16 v[18:21], v[26:29], v[60:63], v[18:21]
  s_setpc_b64 s[60:61]
L_proc_S0_X:
  v_cndmask_b32_e64 v26, 0, v4, s[52:53]
  v_cndmask_b32_e64 v27, 0, v5, s[52:53]
  v_cndmask_b32_e64 v28, 0, v6, s[52:53]
  v_cndmask_b32_e64 v29, 0, v7, s[52:53]
  v_mov_b32 v31, s72
  s_nop 0
  v_mfma_f32_16x16x32_bf16 v[22:25], v[64:67], v[26:29], 0
  v_cndmask_b32_e64 v26, 0, v4, s[54:55]
  v_cndmask_b32_e64 v27, 0, v5, s[54:55]
  v_cndmask_b32_e64 v28, 0, v6, s[54:55]
  v_cndmask_b32_e64 v29, 0, v7, s[54:55]
  s_nop 1
  v_mfma_f32_16x16x32_bf16 v[22:25], v[68:71], v[26:29], v[22:25]
  v_cndmask_b32_e64 v26, 0, v4, s[56:57]
  v_cndmask_b32_e64 v27, 0, v5, s[56:57]
  v_cndmask_b32_e64 v28, 0, v6, s[56:57]
  v_cndmask_b32_e64 v29, 0, v7, s[56:57]
  s_nop 1
  v_mfma_f32_16x16x32_bf16 v[22:25], v[72:75], v[26:29], v[22:25]
  v_cndmask_b32_e64 v26, 0, v4, s[58:59]
  v_cndmask_b32_e64 v27, 0, v5, s[58:59]
  v_cndmask_b32_e64 v28, 0, v6, s[58:59]
  v_cndmask_b32_e64 v29, 0, v7, s[58:59]
  s_nop 1
  v_mfma_f32_16x16x32_bf16 v[22:25], v[76:79], v[26:29], v[22:25]
  s_nop 7
  v_mov_b32_dpp v30, v22 quad_perm:[0,0,0,0] row_mask:0xf bank_mask:0xf
  v_add_f32_dpp v30, v23, v30 quad_perm:[1,1,1,1] row_mask:0xf bank_mask:0xf
  v_add_f32_dpp v30, v24, v30 quad_perm:[2,2,2,2] row_mask:0xf bank_mask:0xf
  v_add_f32_dpp v30, v25, v30 quad_perm:[3,3,3,3] row_mask:0xf bank_mask:0xf
  v_mul_f32 v30, s64, v30
  v_max_f32 v23, v30, v31
  s_nop 1
  v_max_f32_dpp v23, v23, v23 row_ror:4 row_mask:0xf bank_mask:0xf
  s_nop 1
  v_max_f32_dpp v23, v23, v23 row_ror:8 row_mask:0xf bank_mask:0xf
  s_nop 1
  v_max_f32_dpp v23, v23, v23 row_bcast:15 row_mask:0xa bank_mask:0xf
  s_nop 1
  v_max_f32_dpp v23, v23, v23 row_bcast:31 row_mask:0xc bank_mask:0xf
  s_nop 0
  v_readlane_b32 s65, v23, 63
  s_nop 1
  v_subrev_f32 v22, s65, v30
  v_subrev_f32 v23, s65, v31
  v_exp_f32 v22, v22
  v_exp_f32 v23, v23
  s_mov_b32 s72, s65
  s_nop 0
  v_cvt_pk_bf16_f32 v24, v22, v22
  v_mul_f32 v8, v23, v8
  v_mul_f32 v9, v23, v9
  v_mul_f32 v10, v23, v10
  v_mul_f32 v11, v23, v11
  v_fma_f32 v12, v12, v23, v22
  v_and_b32_dpp v25, v24, v3 row_newbcast:0 row_mask:0xf bank_mask:0xf
  v_cndmask_b32_e64 v26, 0, v25, s[74:75]
  v_cndmask_b32_e64 v27, 0, v25, s[76:77]
  v_cndmask_b32_e64 v28, 0, v25, s[78:79]
  v_cndmask_b32_e64 v29, 0, v25, s[80:81]
  s_nop 1
  v_mfma_f32_16x16x32_bf16 v[8:11], v[26:29], v[80:83], v[8:11]
  v_and_b32_dpp v25, v24, v3 row_newbcast:4 row_mask:0xf bank_mask:0xf
  v_cndmask_b32_e64 v26, 0, v25, s[74:75]
  v_cndmask_b32_e64 v27, 0, v25, s[76:77]
  v_cndmask_b32_e64 v28, 0, v25, s[78:79]
  v_cndmask_b32_e64 v29, 0, v25, s[80:81]
  s_nop 1
  v_mfma_f32_16x16x32_bf16 v[8:11], v[26:29], v[84:87], v[8:11]
  v_and_b32_dpp v25, v24, v3 row_newbcast:8 row_mask:0xf bank_mask:0xf
  v_cndmask_b32_e64 v26, 0, v25, s[74:75]
  v_cndmask_b32_e64 v27, 0, v25, s[76:77]
  v_cndmask_b32_e64 v28, 0, v25, s[78:79]
  v_cndmask_b32_e64 v29, 0, v25, s[80:81]
  s_nop 1
  v_mfma_f32_16x16x32_bf16 v[8:11], v[26:29], v[88:91], v[8:11]
  v_and_b32_dpp v25, v24, v3 row_newbcast:12 row_mask:0xf bank_mask:0xf
  v_cndmask_b32_e64 v26, 0, v25, s[74:75]
  v_cndmask_b32_e64 v27, 0, v25, s[76:77]
  v_cndmask_b32_e64 v28, 0, v25, s[78:79]
  v_cndmask_b32_e64 v29, 0, v25, s[80:81]
  s_nop 1
  v_mfma_f32_16x16x32_bf16 v[8:11], v[26:29], v[92:95], v[8:11]
  s_setpc_b64 s[60:61]
L_proc_S0_Y:
  v_cndmask_b32_e64 v26, 0, v14, s[52:53]
  v_cndmask_b32_e64 v27, 0, v15, s[52:53]
  v_cndmask_b32_e64 v28, 0, v16, s[52:53]
  v_cndmask_b32_e64 v29, 0, v17, s[52:53]
  v_mov_b32 v31, s73
  s_nop 0
  v_mfma_f32_16x16x32_bf16 v[22:25], v[64:67], v[26:29], 0
  v_cndmask_b32_e64 v26, 0, v14, s[54:55]
  v_cndmask_b32_e64 v27, 0, v15, s[54:55]
  v_cndmask_b32_e64 v28, 0, v16, s[54:55]
  v_cndmask_b32_e64 v29, 0, v17, s[54:55]
  s_nop 1
  v_mfma_f32_16x16x32_bf16 v[22:25], v[68:71], v[26:29], v[22:25]
  v_cndmask_b32_e64 v26, 0, v14, s[56:57]
  v_cndmask_b32_e64 v27, 0, v15, s[56:57]
  v_cndmask_b32_e64 v28, 0, v16, s[56:57]
  v_cndmask_b32_e64 v29, 0, v17, s[56:57]
  s_nop 1
  v_mfma_f32_16x16x32_bf16 v[22:25], v[72:75], v[26:29], v[22:25]
  v_cndmask_b32_e64 v26, 0, v14, s[58:59]
  v_cndmask_b32_e64 v27, 0, v15, s[58:59]
  v_cndmask_b32_e64 v28, 0, v16, s[58:59]
  v_cndmask_b32_e64 v29, 0, v17, s[58:59]
  s_nop 1
  v_mfma_f32_16x16x32_bf16 v[22:25], v[76:79], v[26:29], v[22:25]
  s_nop 7
  v_mov_b32_dpp v30, v22 quad_perm:[0,0,0,0] row_mask:0xf bank_mask:0xf
  v_add_f32_dpp v30, v23, v30 quad_perm:[1,1,1,1] row_mask:0xf bank_mask:0xf
  v_add_f32_dpp v30, v24, v30 quad_perm:[2,2,2,2] row_mask:0xf bank_mask:0xf
  v_add_f32_dpp v30, v25, v30 quad_perm:[3,3,3,3] row_mask:0xf bank_mask:0xf
  v_mul_f32 v30, s64, v30
  v_max_f32 v23, v30, v31
  s_nop 1
  v_max_f32_dpp v23, v23, v23 row_ror:4 row_mask:0xf bank_mask:0xf
  s_nop 1
  v_max_f32_dpp v23, v23, v23 row_ror:8 row_mask:0xf bank_mask:0xf
  s_nop 1
  v_max_f32_dpp v23, v23, v23 row_bcast:15 row_mask:0xa bank_mask:0xf
  s_nop 1
  v_max_f32_dpp v23, v23, v23 row_bcast:31 row_mask:0xc bank_mask:0xf
  s_nop 0
  v_readlane_b32 s65, v23, 63
  s_nop 1
  v_subrev_f32 v22, s65, v30
  v_subrev_f32 v23, s65, v31
  v_exp_f32 v22, v22
  v_exp_f32 v23, v23
  s_mov_b32 s73, s65
  s_nop 0
  v_cvt_pk_bf16_f32 v24, v22, v22
  v_mul_f32 v18, v23, v18
  v_mul_f32 v19, v23, v19
  v_mul_f32 v20, v23, v20
  v_mul_f32 v21, v23, v21
  v_fma_f32 v13, v13, v23, v22
  v_and_b32_dpp v25, v24, v3 row_newbcast:0 row_mask:0xf bank_mask:0xf
  v_cndmask_b32_e64 v26, 0, v25, s[74:75]
  v_cndmask_b32_e64 v27, 0, v25, s[76:77]
  v_cndmask_b32_e64 v28, 0, v25, s[78:79]
  v_cndmask_b32_e64 v29, 0, v25, s[80:81]
  s_nop 1
  v_mfma_f32_16x16x32_bf16 v[18:21], v[26:29], v[80:83], v[18:21]
  v_and_b32_dpp v25, v24, v3 row_newbcast:4 row_mask:0xf bank_mask:0xf
  v_cndmask_b32_e64 v26, 0, v25, s[74:75]
  v_cndmask_b32_e64 v27, 0, v25, s[76:77]
  v_cndmask_b32_e64 v28, 0, v25, s[78:79]
  v_cndmask_b32_e64 v29, 0, v25, s[80:81]
  s_nop 1
  v_mfma_f32_16x16x32_bf16 v[18:21], v[26:29], v[84:87], v[18:21]
  v_and_b32_dpp v25, v24, v3 row_newbcast:8 row_mask:0xf bank_mask:0xf
  v_cndmask_b32_e64 v26, 0, v25, s[74:75]
  v_cndmask_b32_e64 v27, 0, v25, s[76:77]
  v_cndmask_b32_e64 v28, 0, v25, s[78:79]
  v_cndmask_b32_e64 v29, 0, v25, s[80:81]
  s_nop 1
  v_mfma_f32_16x16x32_bf16 v[18:21], v[26:29], v[88:91], v[18:21]
  v_and_b32_dpp v25, v24, v3 row_newbcast:12 row_mask:0xf bank_mask:0xf
  v_cndmask_b32_e64 v26, 0, v25, s[74:75]
  v_cndmask_b32_e64 v27, 0, v25, s[76:77]
  v_cndmask_b32_e64 v28, 0, v25, s[78:79]
  v_cndmask_b32_e64 v29, 0, v25, s[80:81]
  s_nop 1
  v_mfma_f32_16x16x32_bf16 v[18:21], v[26:29], v[92:95], v[18:21]
  s_setpc_b64 s[60:61]
L_proc_S1_X:
  v_cndmask_b32_e64 v26, 0, v4, s[52:53]
  v_cndmask_b32_e64 v27, 0, v5, s[52:53]
  v_cndmask_b32_e64 v28, 0, v6, s[52:53]
  v_cndmask_b32_e64 v29, 0, v7, s[52:53]
  v_mov_b32 v31, s72
  s_nop 0
  v_mfma_f32_16x16x32_bf16 v[22:25], v[96:99], v[26:29], 0
  v_cndmask_b32_e64 v26, 0, v4, s[54:55]
  v_cndmask_b32_e64 v27, 0, v5, s[54:55]
  v_cndmask_b32_e64 v28, 0, v6, s[54:55]
  v_cndmask_b32_e64 v29, 0, v7, s[54:55]
  s_nop 1
  v_mfma_f32_16x16x32_bf16 v[22:25], v[100:103], v[26:29], v[22:25]
  v_cndmask_b32_e64 v26, 0, v4, s[56:57]
  v_cndmask_b32_e64 v27, 0, v5, s[56:57]
  v_cndmask_b32_e64 v28, 0, v6, s[56:57]
  v_cndmask_b32_e64 v29, 0, v7, s[56:57]
  s_nop 1
  v_mfma_f32_16x16x32_bf16 v[22:25], v[104:107], v[26:29], v[22:25]
  v_cndmask_b32_e64 v26, 0, v4, s[58:59]
  v_cndmask_b32_e64 v27, 0, v5, s[58:59]
  v_cndmask_b32_e64 v28, 0, v6, s[58:59]
  v_cndmask_b32_e64 v29, 0, v7, s[58:59]
  s_nop 1
  v_mfma_f32_16x16x32_bf16 v[22:25], v[108:111], v[26:29], v[22:25]
  s_nop 7
  v_mov_b32_dpp v30, v22 quad_perm:[0,0,0,0] row_mask:0xf bank_mask:0xf
  v_add_f32_dpp v30, v23, v30 quad_perm:[1,1,1,1] row_mask:0xf bank_mask:0xf
  v_add_f32_dpp v30, v24, v30 quad_perm:[2,2,2,2] row_mask:0xf bank_mask:0xf
  v_add_f32_dpp v30, v25, v30 quad_perm:[3,3,3,3] row_mask:0xf bank_mask:0xf
  v_mul_f32 v30, s64, v30
  v_max_f32 v23, v30, v31
  s_nop 1
  v_max_f32_dpp v23, v23, v23 row_ror:4 row_mask:0xf bank_mask:0xf
  s_nop 1
  v_max_f32_dpp v23, v23, v23 row_ror:8 row_mask:0xf bank_mask:0xf
  s_nop 1
  v_max_f32_dpp v23, v23, v23 row_bcast:15 row_mask:0xa bank_mask:0xf
  s_nop 1
  v_max_f32_dpp v23, v23, v23 row_bcast:31 row_mask:0xc bank_mask:0xf
  s_nop 0
  v_readlane_b32 s65, v23, 63
  s_nop 1
  v_subrev_f32 v22, s65, v30
  v_subrev_f32 v23, s65, v31
  v_exp_f32 v22, v22
  v_exp_f32 v23, v23
  s_mov_b32 s72, s65
  s_nop 0
  v_cvt_pk_bf16_f32 v24, v22, v22
  v_mul_f32 v8, v23, v8
  v_mul_f32 v9, v23, v9
  v_mul_f32 v10, v23, v10
  v_mul_f32 v11, v23, v11
  v_fma_f32 v12, v12, v23, v22
  v_and_b32_dpp v25, v24, v3 row_newbcast:0 row_mask:0xf bank_mask:0xf
  v_cndmask_b32_e64 v26, 0, v25, s[74:75]
  v_cndmask_b32_e64 v27, 0, v25, s[76:77]
  v_cndmask_b32_e64 v28, 0, v25, s[78:79]
  v_cndmask_b32_e64 v29, 0, v25, s[80:81]
  s_nop 1
  v_mfma_f32_16x16x32_bf16 v[8:11], v[26:29], v[112:115], v[8:11]
  v_and_b32_dpp v25, v24, v3 row_newbcast:4 row_mask:0xf bank_mask:0xf
  v_cndmask_b32_e64 v26, 0, v25, s[74:75]
  v_cndmask_b32_e64 v27, 0, v25, s[76:77]
  v_cndmask_b32_e64 v28, 0, v25, s[78:79]
  v_cndmask_b32_e64 v29, 0, v25, s[80:81]
  s_nop 1
  v_mfma_f32_16x16x32_bf16 v[8:11], v[26:29], v[116:119], v[8:11]
  v_and_b32_dpp v25, v24, v3 row_newbcast:8 row_mask:0xf bank_mask:0xf
  v_cndmask_b32_e64 v26, 0, v25, s[74:75]
  v_cndmask_b32_e64 v27, 0, v25, s[76:77]
  v_cndmask_b32_e64 v28, 0, v25, s[78:79]
  v_cndmask_b32_e64 v29, 0, v25, s[80:81]
  s_nop 1
  v_mfma_f32_16x16x32_bf16 v[8:11], v[26:29], v[120:123], v[8:11]
  v_and_b32_dpp v25, v24, v3 row_newbcast:12 row_mask:0xf bank_mask:0xf
  v_cndmask_b32_e64 v26, 0, v25, s[74:75]
  v_cndmask_b32_e64 v27, 0, v25, s[76:77]
  v_cndmask_b32_e64 v28, 0, v25, s[78:79]
  v_cndmask_b32_e64 v29, 0, v25, s[80:81]
  s_nop 1
  v_mfma_f32_16x16x32_bf16 v[8:11], v[26:29], v[124:127], v[8:11]
  s_setpc_b64 s[60:61]
L_proc_S1_Y:
  v_cndmask_b32_e64 v26, 0, v14, s[52:53]
  v_cndmask_b32_e64 v27, 0, v15, s[52:53]
  v_cndmask_b32_e64 v28, 0, v16, s[52:53]
  v_cndmask_b32_e64 v29, 0, v17, s[52:53]
  v_mov_b32 v31, s73
  s_nop 0
  v_mfma_f32_16x16x32_bf16 v[22:25], v[96:99], v[26:29], 0
  v_cndmask_b32_e64 v26, 0, v14, s[54:55]
  v_cndmask_b32_e64 v27, 0, v15, s[54:55]
  v_cndmask_b32_e64 v28, 0, v16, s[54:55]
  v_cndmask_b32_e64 v29, 0, v17, s[54:55]
  s_nop 1
  v_mfma_f32_16x16x32_bf16 v[22:25], v[100:103], v[26:29], v[22:25]
  v_cndmask_b32_e64 v26, 0, v14, s[56:57]
  v_cndmask_b32_e64 v27, 0, v15, s[56:57]
  v_cndmask_b32_e64 v28, 0, v16, s[56:57]
  v_cndmask_b32_e64 v29, 0, v17, s[56:57]
  s_nop 1
  v_mfma_f32_16x16x32_bf16 v[22:25], v[104:107], v[26:29], v[22:25]
  v_cndmask_b32_e64 v26, 0, v14, s[58:59]
  v_cndmask_b32_e64 v27, 0, v15, s[58:59]
  v_cndmask_b32_e64 v28, 0, v16, s[58:59]
  v_cndmask_b32_e64 v29, 0, v17, s[58:59]
  s_nop 1
  v_mfma_f32_16x16x32_bf16 v[22:25], v[108:111], v[26:29], v[22:25]
  s_nop 7
  v_mov_b32_dpp v30, v22 quad_perm:[0,0,0,0] row_mask:0xf bank_mask:0xf
  v_add_f32_dpp v30, v23, v30 quad_perm:[1,1,1,1] row_mask:0xf bank_mask:0xf
  v_add_f32_dpp v30, v24, v30 quad_perm:[2,2,2,2] row_mask:0xf bank_mask:0xf
  v_add_f32_dpp v30, v25, v30 quad_perm:[3,3,3,3] row_mask:0xf bank_mask:0xf
  v_mul_f32 v30, s64, v30
  v_max_f32 v23, v30, v31
  s_nop 1
  v_max_f32_dpp v23, v23, v23 row_ror:4 row_mask:0xf bank_mask:0xf
  s_nop 1
  v_max_f32_dpp v23, v23, v23 row_ror:8 row_mask:0xf bank_mask:0xf
  s_nop 1
  v_max_f32_dpp v23, v23, v23 row_bcast:15 row_mask:0xa bank_mask:0xf
  s_nop 1
  v_max_f32_dpp v23, v23, v23 row_bcast:31 row_mask:0xc bank_mask:0xf
  s_nop 0
  v_readlane_b32 s65, v23, 63
  s_nop 1
  v_subrev_f32 v22, s65, v30
  v_subrev_f32 v23, s65, v31
  v_exp_f32 v22, v22
  v_exp_f32 v23, v23
  s_mov_b32 s73, s65
  s_nop 0
  v_cvt_pk_bf16_f32 v24, v22, v22
  v_mul_f32 v18, v23, v18
  v_mul_f32 v19, v23, v19
  v_mul_f32 v20, v23, v20
  v_mul_f32 v21, v23, v21
  v_fma_f32 v13, v13, v23, v22
  v_and_b32_dpp v25, v24, v3 row_newbcast:0 row_mask:0xf bank_mask:0xf
  v_cndmask_b32_e64 v26, 0, v25, s[74:75]
  v_cndmask_b32_e64 v27, 0, v25, s[76:77]
  v_cndmask_b32_e64 v28, 0, v25, s[78:79]
  v_cndmask_b32_e64 v29, 0, v25, s[80:81]
  s_nop 1
  v_mfma_f32_16x16x32_bf16 v[18:21], v[26:29], v[112:115], v[18:21]
  v_and_b32_dpp v25, v24, v3 row_newbcast:4 row_mask:0xf bank_mask:0xf
  v_cndmask_b32_e64 v26, 0, v25, s[74:75]
  v_cndmask_b32_e64 v27, 0, v25, s[76:77]
  v_cndmask_b32_e64 v28, 0, v25, s[78:79]
  v_cndmask_b32_e64 v29, 0, v25, s[80:81]
  s_nop 1
  v_mfma_f32_16x16x32_bf16 v[18:21], v[26:29], v[116:119], v[18:21]
  v_and_b32_dpp v25, v24, v3 row_newbcast:8 row_mask:0xf bank_mask:0xf
  v_cndmask_b32_e64 v26, 0, v25, s[74:75]
  v_cndmask_b32_e64 v27, 0, v25, s[76:77]
  v_cndmask_b32_e64 v28, 0, v25, s[78:79]
  v_cndmask_b32_e64 v29, 0, v25, s[80:81]
  s_nop 1
  v_mfma_f32_16x16x32_bf16 v[18:21], v[26:29], v[120:123], v[18:21]
  v_and_b32_dpp v25, v24, v3 row_newbcast:12 row_mask:0xf bank_mask:0xf
  v_cndmask_b32_e64 v26, 0, v25, s[74:75]
  v_cndmask_b32_e64 v27, 0, v25, s[76:77]
  v_cndmask_b32_e64 v28, 0, v25, s[78:79]
  v_cndmask_b32_e64 v29, 0, v25, s[80:81]
  s_nop 1
  v_mfma_f32_16x16x32_bf16 v[18:21], v[26:29], v[124:127], v[18:21]
  s_setpc_b64 s[60:61]
L_proc_S10_X:
  v_cndmask_b32_e64 v26, 0, v4, s[52:53]
  v_cndmask_b32_e64 v27, 0, v5, s[52:53]
  v_cndmask_b32_e64 v28, 0, v6, s[52:53]
  v_cndmask_b32_e64 v29, 0, v7, s[52:53]
  v_mov_b32 v31, s72
  s_nop 0
  v_mfma_f32_16x16x32_bf16 v[22:25], a[128:131], v[26:29], 0
  v_cndmask_b32_e64 v26, 0, v4, s[54:55]
  v_cndmask_b32_e64 v27, 0, v5, s[54:55]
  v_cndmask_b32_e64 v28, 0, v6, s[54:55]
  v_cndmask_b32_e64 v29, 0, v7, s[54:55]
  s_nop 1
  v_mfma_f32_16x16x32_bf16 v[22:25], a[132:135], v[26:29], v[22:25]
  v_cndmask_b32_e64 v26, 0, v4, s[56:57]
  v_cndmask_b32_e64 v27, 0, v5, s[56:57]
  v_cndmask_b32_e64 v28, 0, v6, s[56:57]
  v_cndmask_b32_e64 v29, 0, v7, s[56:57]
  s_nop 1
  v_mfma_f32_16x16x32_bf16 v[22:25], a[136:139], v[26:29], v[22:25]
  v_cndmask_b32_e64 v26, 0, v4, s[58:59]
  v_cndmask_b32_e64 v27, 0, v5, s[58:59]
  v_cndmask_b32_e64 v28, 0, v6, s[58:59]
  v_cndmask_b32_e64 v29, 0, v7, s[58:59]
  s_nop 1
  v_mfma_f32_16x16x32_bf16 v[22:25], a[140:143], v[26:29], v[22:25]
  s_nop 7
  v_mov_b32_dpp v30, v22 quad_perm:[0,0,0,0] row_mask:0xf bank_mask:0xf
  v_add_f32_dpp v30, v23, v30 quad_perm:[1,1,1,1] row_mask:0xf bank_mask:0xf
  v_add_f32_dpp v30, v24, v30 quad_perm:[2,2,2,2] row_mask:0xf bank_mask:0xf
  v_add_f32_dpp v30, v25, v30 quad_perm:[3,3,3,3] row_mask:0xf bank_mask:0xf
  v_mul_f32 v30, s64, v30
  v_max_f32 v23, v30, v31
  s_nop 1
  v_max_f32_dpp v23, v23, v23 row_ror:4 row_mask:0xf bank_mask:0xf
  s_nop 1
  v_max_f32_dpp v23, v23, v23 row_ror:8 row_mask:0xf bank_mask:0xf
  s_nop 1
  v_max_f32_dpp v23, v23, v23 row_bcast:15 row_mask:0xa bank_mask:0xf
  s_nop 1
  v_max_f32_dpp v23, v23, v23 row_bcast:31 row_mask:0xc bank_mask:0xf
  s_nop 0
  v_readlane_b32 s65, v23, 63
  s_nop 1
  v_subrev_f32 v22, s65, v30
  v_subrev_f32 v23, s65, v31
  v_exp_f32 v22, v22
  v_exp_f32 v23, v23
  s_mov_b32 s72, s65
  s_nop 0
  v_cvt_pk_bf16_f32 v24, v22, v22
  v_mul_f32 v8, v23, v8
  v_mul_f32 v9, v23, v9
  v_mul_f32 v10, v23, v10
  v_mul_f32 v11, v23, v11
  v_fma_f32 v12, v12, v23, v22
  v_and_b32_dpp v25, v24, v3 row_newbcast:0 row_mask:0xf bank_mask:0xf
  v_cndmask_b32_e64 v26, 0, v25, s[74:75]
  v_cndmask_b32_e64 v27, 0, v25, s[76:77]
  v_cndmask_b32_e64 v28, 0, v25, s[78:79]
  v_cndmask_b32_e64 v29, 0, v25, s[80:81]
  s_nop 1
  v_mfma_f32_16x16x32_bf16 v[8:11], v[26:29], a[144:147], v[8:11]
  v_and_b32_dpp v25, v24, v3 row_newbcast:4 row_mask:0xf bank_mask:0xf
  v_cndmask_b32_e64 v26, 0, v25, s[74:75]
  v_cndmask_b32_e64 v27, 0, v25, s[76:77]
  v_cndmask_b32_e64 v28, 0, v25, s[78:79]
  v_cndmask_b32_e64 v29, 0, v25, s[80:81]
  s_nop 1
  v_mfma_f32_16x16x32_bf16 v[8:11], v[26:29], a[148:151], v[8:11]
  v_and_b32_dpp v25, v24, v3 row_newbcast:8 row_mask:0xf bank_mask:0xf
  v_cndmask_b32_e64 v26, 0, v25, s[74:75]
  v_cndmask_b32_e64 v27, 0, v25, s[76:77]
  v_cndmask_b32_e64 v28, 0, v25, s[78:79]
  v_cndmask_b32_e64 v29, 0, v25, s[80:81]
  s_nop 1
  v_mfma_f32_16x16x32_bf16 v[8:11], v[26:29], a[152:155], v[8:11]
  v_and_b32_dpp v25, v24, v3 row_newbcast:12 row_mask:0xf bank_mask:0xf
  v_cndmask_b32_e64 v26, 0, v25, s[74:75]
  v_cndmask_b32_e64 v27, 0, v25, s[76:77]
  v_cndmask_b32_e64 v28, 0, v25, s[78:79]
  v_cndmask_b32_e64 v29, 0, v25, s[80:81]
  s_nop 1
  v_mfma_f32_16x16x32_bf16 v[8:11], v[26:29], a[156:159], v[8:11]
  s_setpc_b64 s[60:61]
L_proc_S10_Y:
  v_cndmask_b32_e64 v26, 0, v14, s[52:53]
  v_cndmask_b32_e64 v27, 0, v15, s[52:53]
  v_cndmask_b32_e64 v28, 0, v16, s[52:53]
  v_cndmask_b32_e64 v29, 0, v17, s[52:53]
  v_mov_b32 v31, s73
  s_nop 0
  v_mfma_f32_16x16x32_bf16 v[22:25], a[128:131], v[26:29], 0
  v_cndmask_b32_e64 v26, 0, v14, s[54:55]
  v_cndmask_b32_e64 v27, 0, v15, s[54:55]
  v_cndmask_b32_e64 v28, 0, v16, s[54:55]
  v_cndmask_b32_e64 v29, 0, v17, s[54:55]
  s_nop 1
  v_mfma_f32_16x16x32_bf16 v[22:25], a[132:135], v[26:29], v[22:25]
  v_cndmask_b32_e64 v26, 0, v14, s[56:57]
  v_cndmask_b32_e64 v27, 0, v15, s[56:57]
  v_cndmask_b32_e64 v28, 0, v16, s[56:57]
  v_cndmask_b32_e64 v29, 0, v17, s[56:57]
  s_nop 1
  v_mfma_f32_16x16x32_bf16 v[22:25], a[136:139], v[26:29], v[22:25]
  v_cndmask_b32_e64 v26, 0, v14, s[58:59]
  v_cndmask_b32_e64 v27, 0, v15, s[58:59]
  v_cndmask_b32_e64 v28, 0, v16, s[58:59]
  v_cndmask_b32_e64 v29, 0, v17, s[58:59]
  s_nop 1
  v_mfma_f32_16x16x32_bf16 v[22:25], a[140:143], v[26:29], v[22:25]
  s_nop 7
  v_mov_b32_dpp v30, v22 quad_perm:[0,0,0,0] row_mask:0xf bank_mask:0xf
  v_add_f32_dpp v30, v23, v30 quad_perm:[1,1,1,1] row_mask:0xf bank_mask:0xf
  v_add_f32_dpp v30, v24, v30 quad_perm:[2,2,2,2] row_mask:0xf bank_mask:0xf
  v_add_f32_dpp v30, v25, v30 quad_perm:[3,3,3,3] row_mask:0xf bank_mask:0xf
  v_mul_f32 v30, s64, v30
  v_max_f32 v23, v30, v31
  s_nop 1
  v_max_f32_dpp v23, v23, v23 row_ror:4 row_mask:0xf bank_mask:0xf
  s_nop 1
  v_max_f32_dpp v23, v23, v23 row_ror:8 row_mask:0xf bank_mask:0xf
  s_nop 1
  v_max_f32_dpp v23, v23, v23 row_bcast:15 row_mask:0xa bank_mask:0xf
  s_nop 1
  v_max_f32_dpp v23, v23, v23 row_bcast:31 row_mask:0xc bank_mask:0xf
  s_nop 0
  v_readlane_b32 s65, v23, 63
  s_nop 1
  v_subrev_f32 v22, s65, v30
  v_subrev_f32 v23, s65, v31
  v_exp_f32 v22, v22
  v_exp_f32 v23, v23
  s_mov_b32 s73, s65
  s_nop 0
  v_cvt_pk_bf16_f32 v24, v22, v22
  v_mul_f32 v18, v23, v18
  v_mul_f32 v19, v23, v19
  v_mul_f32 v20, v23, v20
  v_mul_f32 v21, v23, v21
  v_fma_f32 v13, v13, v23, v22
  v_and_b32_dpp v25, v24, v3 row_newbcast:0 row_mask:0xf bank_mask:0xf
  v_cndmask_b32_e64 v26, 0, v25, s[74:75]
  v_cndmask_b32_e64 v27, 0, v25, s[76:77]
  v_cndmask_b32_e64 v28, 0, v25, s[78:79]
  v_cndmask_b32_e64 v29, 0, v25, s[80:81]
  s_nop 1
  v_mfma_f32_16x16x32_bf16 v[18:21], v[26:29], a[144:147], v[18:21]
  v_and_b32_dpp v25, v24, v3 row_newbcast:4 row_mask:0xf bank_mask:0xf
  v_cndmask_b32_e64 v26, 0, v25, s[74:75]
  v_cndmask_b32_e64 v27, 0, v25, s[76:77]
  v_cndmask_b32_e64 v28, 0, v25, s[78:79]
  v_cndmask_b32_e64 v29, 0, v25, s[80:81]
  s_nop 1
  v_mfma_f32_16x16x32_bf16 v[18:21], v[26:29], a[148:151], v[18:21]
  v_and_b32_dpp v25, v24, v3 row_newbcast:8 row_mask:0xf bank_mask:0xf
  v_cndmask_b32_e64 v26, 0, v25, s[74:75]
  v_cndmask_b32_e64 v27, 0, v25, s[76:77]
  v_cndmask_b32_e64 v28, 0, v25, s[78:79]
  v_cndmask_b32_e64 v29, 0, v25, s[80:81]
  s_nop 1
  v_mfma_f32_16x16x32_bf16 v[18:21], v[26:29], a[152:155], v[18:21]
  v_and_b32_dpp v25, v24, v3 row_newbcast:12 row_mask:0xf bank_mask:0xf
  v_cndmask_b32_e64 v26, 0, v25, s[74:75]
  v_cndmask_b32_e64 v27, 0, v25, s[76:77]
  v_cndmask_b32_e64 v28, 0, v25, s[78:79]
  v_cndmask_b32_e64 v29, 0, v25, s[80:81]
  s_nop 1
  v_mfma_f32_16x16x32_bf16 v[18:21], v[26:29], a[156:159], v[18:21]
  s_setpc_b64 s[60:61]
L_proc_S11_X:
  v_cndmask_b32_e64 v26, 0, v4, s[52:53]
  v_cndmask_b32_e64 v27, 0, v5, s[52:53]
  v_cndmask_b32_e64 v28, 0, v6, s[52:53]
  v_cndmask_b32_e64 v29, 0, v7, s[52:53]
  v_mov_b32 v31, s72
  s_nop 0
  v_mfma_f32_16x16x32_bf16 v[22:25], a[160:163], v[26:29], 0
  v_cndmask_b32_e64 v26, 0, v4, s[54:55]
  v_cndmask_b32_e64 v27, 0, v5, s[54:55]
  v_cndmask_b32_e64 v28, 0, v6, s[54:55]
  v_cndmask_b32_e64 v29, 0, v7, s[54:55]
  s_nop 1
  v_mfma_f32_16x16x32_bf16 v[22:25], a[164:167], v[26:29], v[22:25]
  v_cndmask_b32_e64 v26, 0, v4, s[56:57]
  v_cndmask_b32_e64 v27, 0, v5, s[56:57]
  v_cndmask_b32_e64 v28, 0, v6, s[56:57]
  v_cndmask_b32_e64 v29, 0, v7, s[56:57]
  s_nop 1
  v_mfma_f32_16x16x32_bf16 v[22:25], a[168:171], v[26:29], v[22:25]
  v_cndmask_b32_e64 v26, 0, v4, s[58:59]
  v_cndmask_b32_e64 v27, 0, v5, s[58:59]
  v_cndmask_b32_e64 v28, 0, v6, s[58:59]
  v_cndmask_b32_e64 v29, 0, v7, s[58:59]
  s_nop 1
  v_mfma_f32_16x16x32_bf16 v[22:25], a[172:175], v[26:29], v[22:25]
  s_nop 7
  v_mov_b32_dpp v30, v22 quad_perm:[0,0,0,0] row_mask:0xf bank_mask:0xf
  v_add_f32_dpp v30, v23, v30 quad_perm:[1,1,1,1] row_mask:0xf bank_mask:0xf
  v_add_f32_dpp v30, v24, v30 quad_perm:[2,2,2,2] row_mask:0xf bank_mask:0xf
  v_add_f32_dpp v30, v25, v30 quad_perm:[3,3,3,3] row_mask:0xf bank_mask:0xf
  v_mul_f32 v30, s64, v30
  v_max_f32 v23, v30, v31
  s_nop 1
  v_max_f32_dpp v23, v23, v23 row_ror:4 row_mask:0xf bank_mask:0xf
  s_nop 1
  v_max_f32_dpp v23, v23, v23 row_ror:8 row_mask:0xf bank_mask:0xf
  s_nop 1
  v_max_f32_dpp v23, v23, v23 row_bcast:15 row_mask:0xa bank_mask:0xf
  s_nop 1
  v_max_f32_dpp v23, v23, v23 row_bcast:31 row_mask:0xc bank_mask:0xf
  s_nop 0
  v_readlane_b32 s65, v23, 63
  s_nop 1
  v_subrev_f32 v22, s65, v30
  v_subrev_f32 v23, s65, v31
  v_exp_f32 v22, v22
  v_exp_f32 v23, v23
  s_mov_b32 s72, s65
  s_nop 0
  v_cvt_pk_bf16_f32 v24, v22, v22
  v_mul_f32 v8, v23, v8
  v_mul_f32 v9, v23, v9
  v_mul_f32 v10, v23, v10
  v_mul_f32 v11, v23, v11
  v_fma_f32 v12, v12, v23, v22
  v_and_b32_dpp v25, v24, v3 row_newbcast:0 row_mask:0xf bank_mask:0xf
  v_cndmask_b32_e64 v26, 0, v25, s[74:75]
  v_cndmask_b32_e64 v27, 0, v25, s[76:77]
  v_cndmask_b32_e64 v28, 0, v25, s[78:79]
  v_cndmask_b32_e64 v29, 0, v25, s[80:81]
  s_nop 1
  v_mfma_f32_16x16x32_bf16 v[8:11], v[26:29], a[176:179], v[8:11]
  v_and_b32_dpp v25, v24, v3 row_newbcast:4 row_mask:0xf bank_mask:0xf
  v_cndmask_b32_e64 v26, 0, v25, s[74:75]
  v_cndmask_b32_e64 v27, 0, v25, s[76:77]
  v_cndmask_b32_e64 v28, 0, v25, s[78:79]
  v_cndmask_b32_e64 v29, 0, v25, s[80:81]
  s_nop 1
  v_mfma_f32_16x16x32_bf16 v[8:11], v[26:29], a[180:183], v[8:11]
  v_and_b32_dpp v25, v24, v3 row_newbcast:8 row_mask:0xf bank_mask:0xf
  v_cndmask_b32_e64 v26, 0, v25, s[74:75]
  v_cndmask_b32_e64 v27, 0, v25, s[76:77]
  v_cndmask_b32_e64 v28, 0, v25, s[78:79]
  v_cndmask_b32_e64 v29, 0, v25, s[80:81]
  s_nop 1
  v_mfma_f32_16x16x32_bf16 v[8:11], v[26:29], a[184:187], v[8:11]
  v_and_b32_dpp v25, v24, v3 row_newbcast:12 row_mask:0xf bank_mask:0xf
  v_cndmask_b32_e64 v26, 0, v25, s[74:75]
  v_cndmask_b32_e64 v27, 0, v25, s[76:77]
  v_cndmask_b32_e64 v28, 0, v25, s[78:79]
  v_cndmask_b32_e64 v29, 0, v25, s[80:81]
  s_nop 1
  v_mfma_f32_16x16x32_bf16 v[8:11], v[26:29], a[188:191], v[8:11]
  s_setpc_b64 s[60:61]
L_proc_S11_Y:
  v_cndmask_b32_e64 v26, 0, v14, s[52:53]
  v_cndmask_b32_e64 v27, 0, v15, s[52:53]
  v_cndmask_b32_e64 v28, 0, v16, s[52:53]
  v_cndmask_b32_e64 v29, 0, v17, s[52:53]
  v_mov_b32 v31, s73
  s_nop 0
  v_mfma_f32_16x16x32_bf16 v[22:25], a[160:163], v[26:29], 0
  v_cndmask_b32_e64 v26, 0, v14, s[54:55]
  v_cndmask_b32_e64 v27, 0, v15, s[54:55]
  v_cndmask_b32_e64 v28, 0, v16, s[54:55]
  v_cndmask_b32_e64 v29, 0, v17, s[54:55]
  s_nop 1
  v_mfma_f32_16x16x32_bf16 v[22:25], a[164:167], v[26:29], v[22:25]
  v_cndmask_b32_e64 v26, 0, v14, s[56:57]
  v_cndmask_b32_e64 v27, 0, v15, s[56:57]
  v_cndmask_b32_e64 v28, 0, v16, s[56:57]
  v_cndmask_b32_e64 v29, 0, v17, s[56:57]
  s_nop 1
  v_mfma_f32_16x16x32_bf16 v[22:25], a[168:171], v[26:29], v[22:25]
  v_cndmask_b32_e64 v26, 0, v14, s[58:59]
  v_cndmask_b32_e64 v27, 0, v15, s[58:59]
  v_cndmask_b32_e64 v28, 0, v16, s[58:59]
  v_cndmask_b32_e64 v29, 0, v17, s[58:59]
  s_nop 1
  v_mfma_f32_16x16x32_bf16 v[22:25], a[172:175], v[26:29], v[22:25]
  s_nop 7
  v_mov_b32_dpp v30, v22 quad_perm:[0,0,0,0] row_mask:0xf bank_mask:0xf
  v_add_f32_dpp v30, v23, v30 quad_perm:[1,1,1,1] row_mask:0xf bank_mask:0xf
  v_add_f32_dpp v30, v24, v30 quad_perm:[2,2,2,2] row_mask:0xf bank_mask:0xf
  v_add_f32_dpp v30, v25, v30 quad_perm:[3,3,3,3] row_mask:0xf bank_mask:0xf
  v_mul_f32 v30, s64, v30
  v_max_f32 v23, v30, v31
  s_nop 1
  v_max_f32_dpp v23, v23, v23 row_ror:4 row_mask:0xf bank_mask:0xf
  s_nop 1
  v_max_f32_dpp v23, v23, v23 row_ror:8 row_mask:0xf bank_mask:0xf
  s_nop 1
  v_max_f32_dpp v23, v23, v23 row_bcast:15 row_mask:0xa bank_mask:0xf
  s_nop 1
  v_max_f32_dpp v23, v23, v23 row_bcast:31 row_mask:0xc bank_mask:0xf
  s_nop 0
  v_readlane_b32 s65, v23, 63
  s_nop 1
  v_subrev_f32 v22, s65, v30
  v_subrev_f32 v23, s65, v31
  v_exp_f32 v22, v22
  v_exp_f32 v23, v23
  s_mov_b32 s73, s65
  s_nop 0
  v_cvt_pk_bf16_f32 v24, v22, v22
  v_mul_f32 v18, v23, v18
  v_mul_f32 v19, v23, v19
  v_mul_f32 v20, v23, v20
  v_mul_f32 v21, v23, v21
  v_fma_f32 v13, v13, v23, v22
  v_and_b32_dpp v25, v24, v3 row_newbcast:0 row_mask:0xf bank_mask:0xf
  v_cndmask_b32_e64 v26, 0, v25, s[74:75]
  v_cndmask_b32_e64 v27, 0, v25, s[76:77]
  v_cndmask_b32_e64 v28, 0, v25, s[78:79]
  v_cndmask_b32_e64 v29, 0, v25, s[80:81]
  s_nop 1
  v_mfma_f32_16x16x32_bf16 v[18:21], v[26:29], a[176:179], v[18:21]
  v_and_b32_dpp v25, v24, v3 row_newbcast:4 row_mask:0xf bank_mask:0xf
  v_cndmask_b32_e64 v26, 0, v25, s[74:75]
  v_cndmask_b32_e64 v27, 0, v25, s[76:77]
  v_cndmask_b32_e64 v28, 0, v25, s[78:79]
  v_cndmask_b32_e64 v29, 0, v25, s[80:81]
  s_nop 1
  v_mfma_f32_16x16x32_bf16 v[18:21], v[26:29], a[180:183], v[18:21]
  v_and_b32_dpp v25, v24, v3 row_newbcast:8 row_mask:0xf bank_mask:0xf
  v_cndmask_b32_e64 v26, 0, v25, s[74:75]
  v_cndmask_b32_e64 v27, 0, v25, s[76:77]
  v_cndmask_b32_e64 v28, 0, v25, s[78:79]
  v_cndmask_b32_e64 v29, 0, v25, s[80:81]
  s_nop 1
  v_mfma_f32_16x16x32_bf16 v[18:21], v[26:29], a[184:187], v[18:21]
  v_and_b32_dpp v25, v24, v3 row_newbcast:12 row_mask:0xf bank_mask:0xf
  v_cndmask_b32_e64 v26, 0, v25, s[74:75]
  v_cndmask_b32_e64 v27, 0, v25, s[76:77]
  v_cndmask_b32_e64 v28, 0, v25, s[78:79]
  v_cndmask_b32_e64 v29, 0, v25, s[80:81]
  s_nop 1
  v_mfma_f32_16x16x32_bf16 v[18:21], v[26:29], a[188:191], v[18:21]
  s_setpc_b64 s[60:61]
L_proc_S12_X:
  v_cndmask_b32_e64 v26, 0, v4, s[52:53]
  v_cndmask_b32_e64 v27, 0, v5, s[52:53]
  v_cndmask_b32_e64 v28, 0, v6, s[52:53]
  v_cndmask_b32_e64 v29, 0, v7, s[52:53]
  v_mov_b32 v31, s72
  s_nop 0
  v_mfma_f32_16x16x32_bf16 v[22:25], a[192:195], v[26:29], 0
  v_cndmask_b32_e64 v26, 0, v4, s[54:55]
  v_cndmask_b32_e64 v27, 0, v5, s[54:55]
  v_cndmask_b32_e64 v28, 0, v6, s[54:55]
  v_cndmask_b32_e64 v29, 0, v7, s[54:55]
  s_nop 1
  v_mfma_f32_16x16x32_bf16 v[22:25], a[196:199], v[26:29], v[22:25]
  v_cndmask_b32_e64 v26, 0, v4, s[56:57]
  v_cndmask_b32_e64 v27, 0, v5, s[56:57]
  v_cndmask_b32_e64 v28, 0, v6, s[56:57]
  v_cndmask_b32_e64 v29, 0, v7, s[56:57]
  s_nop 1
  v_mfma_f32_16x16x32_bf16 v[22:25], a[200:203], v[26:29], v[22:25]
  v_cndmask_b32_e64 v26, 0, v4, s[58:59]
  v_cndmask_b32_e64 v27, 0, v5, s[58:59]
  v_cndmask_b32_e64 v28, 0, v6, s[58:59]
  v_cndmask_b32_e64 v29, 0, v7, s[58:59]
  s_nop 1
  v_mfma_f32_16x16x32_bf16 v[22:25], a[204:207], v[26:29], v[22:25]
  s_nop 7
  v_mov_b32_dpp v30, v22 quad_perm:[0,0,0,0] row_mask:0xf bank_mask:0xf
  v_add_f32_dpp v30, v23, v30 quad_perm:[1,1,1,1] row_mask:0xf bank_mask:0xf
  v_add_f32_dpp v30, v24, v30 quad_perm:[2,2,2,2] row_mask:0xf bank_mask:0xf
  v_add_f32_dpp v30, v25, v30 quad_perm:[3,3,3,3] row_mask:0xf bank_mask:0xf
  v_mul_f32 v30, s64, v30
  v_max_f32 v23, v30, v31
  s_nop 1
  v_max_f32_dpp v23, v23, v23 row_ror:4 row_mask:0xf bank_mask:0xf
  s_nop 1
  v_max_f32_dpp v23, v23, v23 row_ror:8 row_mask:0xf bank_mask:0xf
  s_nop 1
  v_max_f32_dpp v23, v23, v23 row_bcast:15 row_mask:0xa bank_mask:0xf
  s_nop 1
  v_max_f32_dpp v23, v23, v23 row_bcast:31 row_mask:0xc bank_mask:0xf
  s_nop 0
  v_readlane_b32 s65, v23, 63
  s_nop 1
  v_subrev_f32 v22, s65, v30
  v_subrev_f32 v23, s65, v31
  v_exp_f32 v22, v22
  v_exp_f32 v23, v23
  s_mov_b32 s72, s65
  s_nop 0
  v_cvt_pk_bf16_f32 v24, v22, v22
  v_mul_f32 v8, v23, v8
  v_mul_f32 v9, v23, v9
  v_mul_f32 v10, v23, v10
  v_mul_f32 v11, v23, v11
  v_fma_f32 v12, v12, v23, v22
  v_and_b32_dpp v25, v24, v3 row_newbcast:0 row_mask:0xf bank_mask:0xf
  v_cndmask_b32_e64 v26, 0, v25, s[74:75]
  v_cndmask_b32_e64 v27, 0, v25, s[76:77]
  v_cndmask_b32_e64 v28, 0, v25, s[78:79]
  v_cndmask_b32_e64 v29, 0, v25, s[80:81]
  s_nop 1
  v_mfma_f32_16x16x32_bf16 v[8:11], v[26:29], a[208:211], v[8:11]
  v_and_b32_dpp v25, v24, v3 row_newbcast:4 row_mask:0xf bank_mask:0xf
  v_cndmask_b32_e64 v26, 0, v25, s[74:75]
  v_cndmask_b32_e64 v27, 0, v25, s[76:77]
  v_cndmask_b32_e64 v28, 0, v25, s[78:79]
  v_cndmask_b32_e64 v29, 0, v25, s[80:81]
  s_nop 1
  v_mfma_f32_16x16x32_bf16 v[8:11], v[26:29], a[212:215], v[8:11]
  v_and_b32_dpp v25, v24, v3 row_newbcast:8 row_mask:0xf bank_mask:0xf
  v_cndmask_b32_e64 v26, 0, v25, s[74:75]
  v_cndmask_b32_e64 v27, 0, v25, s[76:77]
  v_cndmask_b32_e64 v28, 0, v25, s[78:79]
  v_cndmask_b32_e64 v29, 0, v25, s[80:81]
  s_nop 1
  v_mfma_f32_16x16x32_bf16 v[8:11], v[26:29], a[216:219], v[8:11]
  v_and_b32_dpp v25, v24, v3 row_newbcast:12 row_mask:0xf bank_mask:0xf
  v_cndmask_b32_e64 v26, 0, v25, s[74:75]
  v_cndmask_b32_e64 v27, 0, v25, s[76:77]
  v_cndmask_b32_e64 v28, 0, v25, s[78:79]
  v_cndmask_b32_e64 v29, 0, v25, s[80:81]
  s_nop 1
  v_mfma_f32_16x16x32_bf16 v[8:11], v[26:29], a[220:223], v[8:11]
  s_setpc_b64 s[60:61]
L_proc_S12_Y:
  v_cndmask_b32_e64 v26, 0, v14, s[52:53]
  v_cndmask_b32_e64 v27, 0, v15, s[52:53]
  v_cndmask_b32_e64 v28, 0, v16, s[52:53]
  v_cndmask_b32_e64 v29, 0, v17, s[52:53]
  v_mov_b32 v31, s73
  s_nop 0
  v_mfma_f32_16x16x32_bf16 v[22:25], a[192:195], v[26:29], 0
  v_cndmask_b32_e64 v26, 0, v14, s[54:55]
  v_cndmask_b32_e64 v27, 0, v15, s[54:55]
  v_cndmask_b32_e64 v28, 0, v16, s[54:55]
  v_cndmask_b32_e64 v29, 0, v17, s[54:55]
  s_nop 1
  v_mfma_f32_16x16x32_bf16 v[22:25], a[196:199], v[26:29], v[22:25]
  v_cndmask_b32_e64 v26, 0, v14, s[56:57]
  v_cndmask_b32_e64 v27, 0, v15, s[56:57]
  v_cndmask_b32_e64 v28, 0, v16, s[56:57]
  v_cndmask_b32_e64 v29, 0, v17, s[56:57]
  s_nop 1
  v_mfma_f32_16x16x32_bf16 v[22:25], a[200:203], v[26:29], v[22:25]
  v_cndmask_b32_e64 v26, 0, v14, s[58:59]
  v_cndmask_b32_e64 v27, 0, v15, s[58:59]
  v_cndmask_b32_e64 v28, 0, v16, s[58:59]
  v_cndmask_b32_e64 v29, 0, v17, s[58:59]
  s_nop 1
  v_mfma_f32_16x16x32_bf16 v[22:25], a[204:207], v[26:29], v[22:25]
  s_nop 7
  v_mov_b32_dpp v30, v22 quad_perm:[0,0,0,0] row_mask:0xf bank_mask:0xf
  v_add_f32_dpp v30, v23, v30 quad_perm:[1,1,1,1] row_mask:0xf bank_mask:0xf
  v_add_f32_dpp v30, v24, v30 quad_perm:[2,2,2,2] row_mask:0xf bank_mask:0xf
  v_add_f32_dpp v30, v25, v30 quad_perm:[3,3,3,3] row_mask:0xf bank_mask:0xf
  v_mul_f32 v30, s64, v30
  v_max_f32 v23, v30, v31
  s_nop 1
  v_max_f32_dpp v23, v23, v23 row_ror:4 row_mask:0xf bank_mask:0xf
  s_nop 1
  v_max_f32_dpp v23, v23, v23 row_ror:8 row_mask:0xf bank_mask:0xf
  s_nop 1
  v_max_f32_dpp v23, v23, v23 row_bcast:15 row_mask:0xa bank_mask:0xf
  s_nop 1
  v_max_f32_dpp v23, v23, v23 row_bcast:31 row_mask:0xc bank_mask:0xf
  s_nop 0
  v_readlane_b32 s65, v23, 63
  s_nop 1
  v_subrev_f32 v22, s65, v30
  v_subrev_f32 v23, s65, v31
  v_exp_f32 v22, v22
  v_exp_f32 v23, v23
  s_mov_b32 s73, s65
  s_nop 0
  v_cvt_pk_bf16_f32 v24, v22, v22
  v_mul_f32 v18, v23, v18
  v_mul_f32 v19, v23, v19
  v_mul_f32 v20, v23, v20
  v_mul_f32 v21, v23, v21
  v_fma_f32 v13, v13, v23, v22
  v_and_b32_dpp v25, v24, v3 row_newbcast:0 row_mask:0xf bank_mask:0xf
  v_cndmask_b32_e64 v26, 0, v25, s[74:75]
  v_cndmask_b32_e64 v27, 0, v25, s[76:77]
  v_cndmask_b32_e64 v28, 0, v25, s[78:79]
  v_cndmask_b32_e64 v29, 0, v25, s[80:81]
  s_nop 1
  v_mfma_f32_16x16x32_bf16 v[18:21], v[26:29], a[208:211], v[18:21]
  v_and_b32_dpp v25, v24, v3 row_newbcast:4 row_mask:0xf bank_mask:0xf
  v_cndmask_b32_e64 v26, 0, v25, s[74:75]
  v_cndmask_b32_e64 v27, 0, v25, s[76:77]
  v_cndmask_b32_e64 v28, 0, v25, s[78:79]
  v_cndmask_b32_e64 v29, 0, v25, s[80:81]
  s_nop 1
  v_mfma_f32_16x16x32_bf16 v[18:21], v[26:29], a[212:215], v[18:21]
  v_and_b32_dpp v25, v24, v3 row_newbcast:8 row_mask:0xf bank_mask:0xf
  v_cndmask_b32_e64 v26, 0, v25, s[74:75]
  v_cndmask_b32_e64 v27, 0, v25, s[76:77]
  v_cndmask_b32_e64 v28, 0, v25, s[78:79]
  v_cndmask_b32_e64 v29, 0, v25, s[80:81]
  s_nop 1
  v_mfma_f32_16x16x32_bf16 v[18:21], v[26:29], a[216:219], v[18:21]
  v_and_b32_dpp v25, v24, v3 row_newbcast:12 row_mask:0xf bank_mask:0xf
  v_cndmask_b32_e64 v26, 0, v25, s[74:75]
  v_cndmask_b32_e64 v27, 0, v25, s[76:77]
  v_cndmask_b32_e64 v28, 0, v25, s[78:79]
  v_cndmask_b32_e64 v29, 0, v25, s[80:81]
  s_nop 1
  v_mfma_f32_16x16x32_bf16 v[18:21], v[26:29], a[220:223], v[18:21]
  s_setpc_b64 s[60:61]
L_proc_S13_X:
  v_cndmask_b32_e64 v26, 0, v4, s[52:53]
  v_cndmask_b32_e64 v27, 0, v5, s[52:53]
  v_cndmask_b32_e64 v28, 0, v6, s[52:53]
  v_cndmask_b32_e64 v29, 0, v7, s[52:53]
  v_mov_b32 v31, s72
  s_nop 0
  v_mfma_f32_16x16x32_bf16 v[22:25], a[224:227], v[26:29], 0
  v_cndmask_b32_e64 v26, 0, v4, s[54:55]
  v_cndmask_b32_e64 v27, 0, v5, s[54:55]
  v_cndmask_b32_e64 v28, 0, v6, s[54:55]
  v_cndmask_b32_e64 v29, 0, v7, s[54:55]
  s_nop 1
  v_mfma_f32_16x16x32_bf16 v[22:25], a[228:231], v[26:29], v[22:25]
  v_cndmask_b32_e64 v26, 0, v4, s[56:57]
  v_cndmask_b32_e64 v27, 0, v5, s[56:57]
  v_cndmask_b32_e64 v28, 0, v6, s[56:57]
  v_cndmask_b32_e64 v29, 0, v7, s[56:57]
  s_nop 1
  v_mfma_f32_16x16x32_bf16 v[22:25], a[232:235], v[26:29], v[22:25]
  v_cndmask_b32_e64 v26, 0, v4, s[58:59]
  v_cndmask_b32_e64 v27, 0, v5, s[58:59]
  v_cndmask_b32_e64 v28, 0, v6, s[58:59]
  v_cndmask_b32_e64 v29, 0, v7, s[58:59]
  s_nop 1
  v_mfma_f32_16x16x32_bf16 v[22:25], a[236:239], v[26:29], v[22:25]
  s_nop 7
  v_mov_b32_dpp v30, v22 quad_perm:[0,0,0,0] row_mask:0xf bank_mask:0xf
  v_add_f32_dpp v30, v23, v30 quad_perm:[1,1,1,1] row_mask:0xf bank_mask:0xf
  v_add_f32_dpp v30, v24, v30 quad_perm:[2,2,2,2] row_mask:0xf bank_mask:0xf
  v_add_f32_dpp v30, v25, v30 quad_perm:[3,3,3,3] row_mask:0xf bank_mask:0xf
  v_mul_f32 v30, s64, v30
  v_max_f32 v23, v30, v31
  s_nop 1
  v_max_f32_dpp v23, v23, v23 row_ror:4 row_mask:0xf bank_mask:0xf
  s_nop 1
  v_max_f32_dpp v23, v23, v23 row_ror:8 row_mask:0xf bank_mask:0xf
  s_nop 1
  v_max_f32_dpp v23, v23, v23 row_bcast:15 row_mask:0xa bank_mask:0xf
  s_nop 1
  v_max_f32_dpp v23, v23, v23 row_bcast:31 row_mask:0xc bank_mask:0xf
  s_nop 0
  v_readlane_b32 s65, v23, 63
  s_nop 1
  v_subrev_f32 v22, s65, v30
  v_subrev_f32 v23, s65, v31
  v_exp_f32 v22, v22
  v_exp_f32 v23, v23
  s_mov_b32 s72, s65
  s_nop 0
  v_cvt_pk_bf16_f32 v24, v22, v22
  v_mul_f32 v8, v23, v8
  v_mul_f32 v9, v23, v9
  v_mul_f32 v10, v23, v10
  v_mul_f32 v11, v23, v11
  v_fma_f32 v12, v12, v23, v22
  v_and_b32_dpp v25, v24, v3 row_newbcast:0 row_mask:0xf bank_mask:0xf
  v_cndmask_b32_e64 v26, 0, v25, s[74:75]
  v_cndmask_b32_e64 v27, 0, v25, s[76:77]
  v_cndmask_b32_e64 v28, 0, v25, s[78:79]
  v_cndmask_b32_e64 v29, 0, v25, s[80:81]
  s_nop 1
  v_mfma_f32_16x16x32_bf16 v[8:11], v[26:29], a[240:243], v[8:11]
  v_and_b32_dpp v25, v24, v3 row_newbcast:4 row_mask:0xf bank_mask:0xf
  v_cndmask_b32_e64 v26, 0, v25, s[74:75]
  v_cndmask_b32_e64 v27, 0, v25, s[76:77]
  v_cndmask_b32_e64 v28, 0, v25, s[78:79]
  v_cndmask_b32_e64 v29, 0, v25, s[80:81]
  s_nop 1
  v_mfma_f32_16x16x32_bf16 v[8:11], v[26:29], a[244:247], v[8:11]
  v_and_b32_dpp v25, v24, v3 row_newbcast:8 row_mask:0xf bank_mask:0xf
  v_cndmask_b32_e64 v26, 0, v25, s[74:75]
  v_cndmask_b32_e64 v27, 0, v25, s[76:77]
  v_cndmask_b32_e64 v28, 0, v25, s[78:79]
  v_cndmask_b32_e64 v29, 0, v25, s[80:81]
  s_nop 1
  v_mfma_f32_16x16x32_bf16 v[8:11], v[26:29], a[248:251], v[8:11]
  v_and_b32_dpp v25, v24, v3 row_newbcast:12 row_mask:0xf bank_mask:0xf
  v_cndmask_b32_e64 v26, 0, v25, s[74:75]
  v_cndmask_b32_e64 v27, 0, v25, s[76:77]
  v_cndmask_b32_e64 v28, 0, v25, s[78:79]
  v_cndmask_b32_e64 v29, 0, v25, s[80:81]
  s_nop 1
  v_mfma_f32_16x16x32_bf16 v[8:11], v[26:29], a[252:255], v[8:11]
  s_setpc_b64 s[60:61]
L_proc_S13_Y:
  v_cndmask_b32_e64 v26, 0, v14, s[52:53]
  v_cndmask_b32_e64 v27, 0, v15, s[52:53]
  v_cndmask_b32_e64 v28, 0, v16, s[52:53]
  v_cndmask_b32_e64 v29, 0, v17, s[52:53]
  v_mov_b32 v31, s73
  s_nop 0
  v_mfma_f32_16x16x32_bf16 v[22:25], a[224:227], v[26:29], 0
  v_cndmask_b32_e64 v26, 0, v14, s[54:55]
  v_cndmask_b32_e64 v27, 0, v15, s[54:55]
  v_cndmask_b32_e64 v28, 0, v16, s[54:55]
  v_cndmask_b32_e64 v29, 0, v17, s[54:55]
  s_nop 1
  v_mfma_f32_16x16x32_bf16 v[22:25], a[228:231], v[26:29], v[22:25]
  v_cndmask_b32_e64 v26, 0, v14, s[56:57]
  v_cndmask_b32_e64 v27, 0, v15, s[56:57]
  v_cndmask_b32_e64 v28, 0, v16, s[56:57]
  v_cndmask_b32_e64 v29, 0, v17, s[56:57]
  s_nop 1
  v_mfma_f32_16x16x32_bf16 v[22:25], a[232:235], v[26:29], v[22:25]
  v_cndmask_b32_e64 v26, 0, v14, s[58:59]
  v_cndmask_b32_e64 v27, 0, v15, s[58:59]
  v_cndmask_b32_e64 v28, 0, v16, s[58:59]
  v_cndmask_b32_e64 v29, 0, v17, s[58:59]
  s_nop 1
  v_mfma_f32_16x16x32_bf16 v[22:25], a[236:239], v[26:29], v[22:25]
  s_nop 7
  v_mov_b32_dpp v30, v22 quad_perm:[0,0,0,0] row_mask:0xf bank_mask:0xf
  v_add_f32_dpp v30, v23, v30 quad_perm:[1,1,1,1] row_mask:0xf bank_mask:0xf
  v_add_f32_dpp v30, v24, v30 quad_perm:[2,2,2,2] row_mask:0xf bank_mask:0xf
  v_add_f32_dpp v30, v25, v30 quad_perm:[3,3,3,3] row_mask:0xf bank_mask:0xf
  v_mul_f32 v30, s64, v30
  v_max_f32 v23, v30, v31
  s_nop 1
  v_max_f32_dpp v23, v23, v23 row_ror:4 row_mask:0xf bank_mask:0xf
  s_nop 1
  v_max_f32_dpp v23, v23, v23 row_ror:8 row_mask:0xf bank_mask:0xf
  s_nop 1
  v_max_f32_dpp v23, v23, v23 row_bcast:15 row_mask:0xa bank_mask:0xf
  s_nop 1
  v_max_f32_dpp v23, v23, v23 row_bcast:31 row_mask:0xc bank_mask:0xf
  s_nop 0
  v_readlane_b32 s65, v23, 63
  s_nop 1
  v_subrev_f32 v22, s65, v30
  v_subrev_f32 v23, s65, v31
  v_exp_f32 v22, v22
  v_exp_f32 v23, v23
  s_mov_b32 s73, s65
  s_nop 0
  v_cvt_pk_bf16_f32 v24, v22, v22
  v_mul_f32 v18, v23, v18
  v_mul_f32 v19, v23, v19
  v_mul_f32 v20, v23, v20
  v_mul_f32 v21, v23, v21
  v_fma_f32 v13, v13, v23, v22
  v_and_b32_dpp v25, v24, v3 row_newbcast:0 row_mask:0xf bank_mask:0xf
  v_cndmask_b32_e64 v26, 0, v25, s[74:75]
  v_cndmask_b32_e64 v27, 0, v25, s[76:77]
  v_cndmask_b32_e64 v28, 0, v25, s[78:79]
  v_cndmask_b32_e64 v29, 0, v25, s[80:81]
  s_nop 1
  v_mfma_f32_16x16x32_bf16 v[18:21], v[26:29], a[240:243], v[18:21]
  v_and_b32_dpp v25, v24, v3 row_newbcast:4 row_mask:0xf bank_mask:0xf
  v_cndmask_b32_e64 v26, 0, v25, s[74:75]
  v_cndmask_b32_e64 v27, 0, v25, s[76:77]
  v_cndmask_b32_e64 v28, 0, v25, s[78:79]
  v_cndmask_b32_e64 v29, 0, v25, s[80:81]
  s_nop 1
  v_mfma_f32_16x16x32_bf16 v[18:21], v[26:29], a[244:247], v[18:21]
  v_and_b32_dpp v25, v24, v3 row_newbcast:8 row_mask:0xf bank_mask:0xf
  v_cndmask_b32_e64 v26, 0, v25, s[74:75]
  v_cndmask_b32_e64 v27, 0, v25, s[76:77]
  v_cndmask_b32_e64 v28, 0, v25, s[78:79]
  v_cndmask_b32_e64 v29, 0, v25, s[80:81]
  s_nop 1
  v_mfma_f32_16x16x32_bf16 v[18:21], v[26:29], a[248:251], v[18:21]
  v_and_b32_dpp v25, v24, v3 row_newbcast:12 row_mask:0xf bank_mask:0xf
  v_cndmask_b32_e64 v26, 0, v25, s[74:75]
  v_cndmask_b32_e64 v27, 0, v25, s[76:77]
  v_cndmask_b32_e64 v28, 0, v25, s[78:79]
  v_cndmask_b32_e64 v29, 0, v25, s[80:81]
  s_nop 1
  v_mfma_f32_16x16x32_bf16 v[18:21], v[26:29], a[252:255], v[18:21]
  s_setpc_b64 s[60:61]
L_proc_S2_X:
  v_cndmask_b32_e64 v26, 0, v4, s[52:53]
  v_cndmask_b32_e64 v27, 0, v5, s[52:53]
  v_cndmask_b32_e64 v28, 0, v6, s[52:53]
  v_cndmask_b32_e64 v29, 0, v7, s[52:53]
  v_mov_b32 v31, s72
  s_nop 0
  v_mfma_f32_16x16x32_bf16 v[22:25], v[128:131], v[26:29], 0
  v_cndmask_b32_e64 v26, 0, v4, s[54:55]
  v_cndmask_b32_e64 v27, 0, v5, s[54:55]
  v_cndmask_b32_e64 v28, 0, v6, s[54:55]
  v_cndmask_b32_e64 v29, 0, v7, s[54:55]
  s_nop 1
  v_mfma_f32_16x16x32_bf16 v[22:25], v[132:135], v[26:29], v[22:25]
  v_cndmask_b32_e64 v26, 0, v4, s[56:57]
  v_cndmask_b32_e64 v27, 0, v5, s[56:57]
  v_cndmask_b32_e64 v28, 0, v6, s[56:57]
  v_cndmask_b32_e64 v29, 0, v7, s[56:57]
  s_nop 1
  v_mfma_f32_16x16x32_bf16 v[22:25], v[136:139], v[26:29], v[22:25]
  v_cndmask_b32_e64 v26, 0, v4, s[58:59]
  v_cndmask_b32_e64 v27, 0, v5, s[58:59]
  v_cndmask_b32_e64 v28, 0, v6, s[58:59]
  v_cndmask_b32_e64 v29, 0, v7, s[58:59]
  s_nop 1
  v_mfma_f32_16x16x32_bf16 v[22:25], v[140:143], v[26:29], v[22:25]
  s_nop 7
  v_mov_b32_dpp v30, v22 quad_perm:[0,0,0,0] row_mask:0xf bank_mask:0xf
  v_add_f32_dpp v30, v23, v30 quad_perm:[1,1,1,1] row_mask:0xf bank_mask:0xf
  v_add_f32_dpp v30, v24, v30 quad_perm:[2,2,2,2] row_mask:0xf bank_mask:0xf
  v_add_f32_dpp v30, v25, v30 quad_perm:[3,3,3,3] row_mask:0xf bank_mask:0xf
  v_mul_f32 v30, s64, v30
  v_max_f32 v23, v30, v31
  s_nop 1
  v_max_f32_dpp v23, v23, v23 row_ror:4 row_mask:0xf bank_mask:0xf
  s_nop 1
  v_max_f32_dpp v23, v23, v23 row_ror:8 row_mask:0xf bank_mask:0xf
  s_nop 1
  v_max_f32_dpp v23, v23, v23 row_bcast:15 row_mask:0xa bank_mask:0xf
  s_nop 1
  v_max_f32_dpp v23, v23, v23 row_bcast:31 row_mask:0xc bank_mask:0xf
  s_nop 0
  v_readlane_b32 s65, v23, 63
  s_nop 1
  v_subrev_f32 v22, s65, v30
  v_subrev_f32 v23, s65, v31
  v_exp_f32 v22, v22
  v_exp_f32 v23, v23
  s_mov_b32 s72, s65
  s_nop 0
  v_cvt_pk_bf16_f32 v24, v22, v22
  v_mul_f32 v8, v23, v8
  v_mul_f32 v9, v23, v9
  v_mul_f32 v10, v23, v10
  v_mul_f32 v11, v23, v11
  v_fma_f32 v12, v12, v23, v22
  v_and_b32_dpp v25, v24, v3 row_newbcast:0 row_mask:0xf bank_mask:0xf
  v_cndmask_b32_e64 v26, 0, v25, s[74:75]
  v_cndmask_b32_e64 v27, 0, v25, s[76:77]
  v_cndmask_b32_e64 v28, 0, v25, s[78:79]
  v_cndmask_b32_e64 v29, 0, v25, s[80:81]
  s_nop 1
  v_mfma_f32_16x16x32_bf16 v[8:11], v[26:29], v[144:147], v[8:11]
  v_and_b32_dpp v25, v24, v3 row_newbcast:4 row_mask:0xf bank_mask:0xf
  v_cndmask_b32_e64 v26, 0, v25, s[74:75]
  v_cndmask_b32_e64 v27, 0, v25, s[76:77]
  v_cndmask_b32_e64 v28, 0, v25, s[78:79]
  v_cndmask_b32_e64 v29, 0, v25, s[80:81]
  s_nop 1
  v_mfma_f32_16x16x32_bf16 v[8:11], v[26:29], v[148:151], v[8:11]
  v_and_b32_dpp v25, v24, v3 row_newbcast:8 row_mask:0xf bank_mask:0xf
  v_cndmask_b32_e64 v26, 0, v25, s[74:75]
  v_cndmask_b32_e64 v27, 0, v25, s[76:77]
  v_cndmask_b32_e64 v28, 0, v25, s[78:79]
  v_cndmask_b32_e64 v29, 0, v25, s[80:81]
  s_nop 1
  v_mfma_f32_16x16x32_bf16 v[8:11], v[26:29], v[152:155], v[8:11]
  v_and_b32_dpp v25, v24, v3 row_newbcast:12 row_mask:0xf bank_mask:0xf
  v_cndmask_b32_e64 v26, 0, v25, s[74:75]
  v_cndmask_b32_e64 v27, 0, v25, s[76:77]
  v_cndmask_b32_e64 v28, 0, v25, s[78:79]
  v_cndmask_b32_e64 v29, 0, v25, s[80:81]
  s_nop 1
  v_mfma_f32_16x16x32_bf16 v[8:11], v[26:29], v[156:159], v[8:11]
  s_setpc_b64 s[60:61]
L_proc_S2_Y:
  v_cndmask_b32_e64 v26, 0, v14, s[52:53]
  v_cndmask_b32_e64 v27, 0, v15, s[52:53]
  v_cndmask_b32_e64 v28, 0, v16, s[52:53]
  v_cndmask_b32_e64 v29, 0, v17, s[52:53]
  v_mov_b32 v31, s73
  s_nop 0
  v_mfma_f32_16x16x32_bf16 v[22:25], v[128:131], v[26:29], 0
  v_cndmask_b32_e64 v26, 0, v14, s[54:55]
  v_cndmask_b32_e64 v27, 0, v15, s[54:55]
  v_cndmask_b32_e64 v28, 0, v16, s[54:55]
  v_cndmask_b32_e64 v29, 0, v17, s[54:55]
  s_nop 1
  v_mfma_f32_16x16x32_bf16 v[22:25], v[132:135], v[26:29], v[22:25]
  v_cndmask_b32_e64 v26, 0, v14, s[56:57]
  v_cndmask_b32_e64 v27, 0, v15, s[56:57]
  v_cndmask_b32_e64 v28, 0, v16, s[56:57]
  v_cndmask_b32_e64 v29, 0, v17, s[56:57]
  s_nop 1
  v_mfma_f32_16x16x32_bf16 v[22:25], v[136:139], v[26:29], v[22:25]
  v_cndmask_b32_e64 v26, 0, v14, s[58:59]
  v_cndmask_b32_e64 v27, 0, v15, s[58:59]
  v_cndmask_b32_e64 v28, 0, v16, s[58:59]
  v_cndmask_b32_e64 v29, 0, v17, s[58:59]
  s_nop 1
  v_mfma_f32_16x16x32_bf16 v[22:25], v[140:143], v[26:29], v[22:25]
  s_nop 7
  v_mov_b32_dpp v30, v22 quad_perm:[0,0,0,0] row_mask:0xf bank_mask:0xf
  v_add_f32_dpp v30, v23, v30 quad_perm:[1,1,1,1] row_mask:0xf bank_mask:0xf
  v_add_f32_dpp v30, v24, v30 quad_perm:[2,2,2,2] row_mask:0xf bank_mask:0xf
  v_add_f32_dpp v30, v25, v30 quad_perm:[3,3,3,3] row_mask:0xf bank_mask:0xf
  v_mul_f32 v30, s64, v30
  v_max_f32 v23, v30, v31
  s_nop 1
  v_max_f32_dpp v23, v23, v23 row_ror:4 row_mask:0xf bank_mask:0xf
  s_nop 1
  v_max_f32_dpp v23, v23, v23 row_ror:8 row_mask:0xf bank_mask:0xf
  s_nop 1
  v_max_f32_dpp v23, v23, v23 row_bcast:15 row_mask:0xa bank_mask:0xf
  s_nop 1
  v_max_f32_dpp v23, v23, v23 row_bcast:31 row_mask:0xc bank_mask:0xf
  s_nop 0
  v_readlane_b32 s65, v23, 63
  s_nop 1
  v_subrev_f32 v22, s65, v30
  v_subrev_f32 v23, s65, v31
  v_exp_f32 v22, v22
  v_exp_f32 v23, v23
  s_mov_b32 s73, s65
  s_nop 0
  v_cvt_pk_bf16_f32 v24, v22, v22
  v_mul_f32 v18, v23, v18
  v_mul_f32 v19, v23, v19
  v_mul_f32 v20, v23, v20
  v_mul_f32 v21, v23, v21
  v_fma_f32 v13, v13, v23, v22
  v_and_b32_dpp v25, v24, v3 row_newbcast:0 row_mask:0xf bank_mask:0xf
  v_cndmask_b32_e64 v26, 0, v25, s[74:75]
  v_cndmask_b32_e64 v27, 0, v25, s[76:77]
  v_cndmask_b32_e64 v28, 0, v25, s[78:79]
  v_cndmask_b32_e64 v29, 0, v25, s[80:81]
  s_nop 1
  v_mfma_f32_16x16x32_bf16 v[18:21], v[26:29], v[144:147], v[18:21]
  v_and_b32_dpp v25, v24, v3 row_newbcast:4 row_mask:0xf bank_mask:0xf
  v_cndmask_b32_e64 v26, 0, v25, s[74:75]
  v_cndmask_b32_e64 v27, 0, v25, s[76:77]
  v_cndmask_b32_e64 v28, 0, v25, s[78:79]
  v_cndmask_b32_e64 v29, 0, v25, s[80:81]
  s_nop 1
  v_mfma_f32_16x16x32_bf16 v[18:21], v[26:29], v[148:151], v[18:21]
  v_and_b32_dpp v25, v24, v3 row_newbcast:8 row_mask:0xf bank_mask:0xf
  v_cndmask_b32_e64 v26, 0, v25, s[74:75]
  v_cndmask_b32_e64 v27, 0, v25, s[76:77]
  v_cndmask_b32_e64 v28, 0, v25, s[78:79]
  v_cndmask_b32_e64 v29, 0, v25, s[80:81]
  s_nop 1
  v_mfma_f32_16x16x32_bf16 v[18:21], v[26:29], v[152:155], v[18:21]
  v_and_b32_dpp v25, v24, v3 row_newbcast:12 row_mask:0xf bank_mask:0xf
  v_cndmask_b32_e64 v26, 0, v25, s[74:75]
  v_cndmask_b32_e64 v27, 0, v25, s[76:77]
  v_cndmask_b32_e64 v28, 0, v25, s[78:79]
  v_cndmask_b32_e64 v29, 0, v25, s[80:81]
  s_nop 1
  v_mfma_f32_16x16x32_bf16 v[18:21], v[26:29], v[156:159], v[18:21]
  s_setpc_b64 s[60:61]
L_proc_S3_X:
  v_cndmask_b32_e64 v26, 0, v4, s[52:53]
  v_cndmask_b32_e64 v27, 0, v5, s[52:53]
  v_cndmask_b32_e64 v28, 0, v6, s[52:53]
  v_cndmask_b32_e64 v29, 0, v7, s[52:53]
  v_mov_b32 v31, s72
  s_nop 0
  v_mfma_f32_16x16x32_bf16 v[22:25], v[160:163], v[26:29], 0
  v_cndmask_b32_e64 v26, 0, v4, s[54:55]
  v_cndmask_b32_e64 v27, 0, v5, s[54:55]
  v_cndmask_b32_e64 v28, 0, v6, s[54:55]
  v_cndmask_b32_e64 v29, 0, v7, s[54:55]
  s_nop 1
  v_mfma_f32_16x16x32_bf16 v[22:25], v[164:167], v[26:29], v[22:25]
  v_cndmask_b32_e64 v26, 0, v4, s[56:57]
  v_cndmask_b32_e64 v27, 0, v5, s[56:57]
  v_cndmask_b32_e64 v28, 0, v6, s[56:57]
  v_cndmask_b32_e64 v29, 0, v7, s[56:57]
  s_nop 1
  v_mfma_f32_16x16x32_bf16 v[22:25], v[168:171], v[26:29], v[22:25]
  v_cndmask_b32_e64 v26, 0, v4, s[58:59]
  v_cndmask_b32_e64 v27, 0, v5, s[58:59]
  v_cndmask_b32_e64 v28, 0, v6, s[58:59]
  v_cndmask_b32_e64 v29, 0, v7, s[58:59]
  s_nop 1
  v_mfma_f32_16x16x32_bf16 v[22:25], v[172:175], v[26:29], v[22:25]
  s_nop 7
  v_mov_b32_dpp v30, v22 quad_perm:[0,0,0,0] row_mask:0xf bank_mask:0xf
  v_add_f32_dpp v30, v23, v30 quad_perm:[1,1,1,1] row_mask:0xf bank_mask:0xf
  v_add_f32_dpp v30, v24, v30 quad_perm:[2,2,2,2] row_mask:0xf bank_mask:0xf
  v_add_f32_dpp v30, v25, v30 quad_perm:[3,3,3,3] row_mask:0xf bank_mask:0xf
  v_mul_f32 v30, s64, v30
  v_max_f32 v23, v30, v31
  s_nop 1
  v_max_f32_dpp v23, v23, v23 row_ror:4 row_mask:0xf bank_mask:0xf
  s_nop 1
  v_max_f32_dpp v23, v23, v23 row_ror:8 row_mask:0xf bank_mask:0xf
  s_nop 1
  v_max_f32_dpp v23, v23, v23 row_bcast:15 row_mask:0xa bank_mask:0xf
  s_nop 1
  v_max_f32_dpp v23, v23, v23 row_bcast:31 row_mask:0xc bank_mask:0xf
  s_nop 0
  v_readlane_b32 s65, v23, 63
  s_nop 1
  v_subrev_f32 v22, s65, v30
  v_subrev_f32 v23, s65, v31
  v_exp_f32 v22, v22
  v_exp_f32 v23, v23
  s_mov_b32 s72, s65
  s_nop 0
  v_cvt_pk_bf16_f32 v24, v22, v22
  v_mul_f32 v8, v23, v8
  v_mul_f32 v9, v23, v9
  v_mul_f32 v10, v23, v10
  v_mul_f32 v11, v23, v11
  v_fma_f32 v12, v12, v23, v22
  v_and_b32_dpp v25, v24, v3 row_newbcast:0 row_mask:0xf bank_mask:0xf
  v_cndmask_b32_e64 v26, 0, v25, s[74:75]
  v_cndmask_b32_e64 v27, 0, v25, s[76:77]
  v_cndmask_b32_e64 v28, 0, v25, s[78:79]
  v_cndmask_b32_e64 v29, 0, v25, s[80:81]
  s_nop 1
  v_mfma_f32_16x16x32_bf16 v[8:11], v[26:29], v[176:179], v[8:11]
  v_and_b32_dpp v25, v24, v3 row_newbcast:4 row_mask:0xf bank_mask:0xf
  v_cndmask_b32_e64 v26, 0, v25, s[74:75]
  v_cndmask_b32_e64 v27, 0, v25, s[76:77]
  v_cndmask_b32_e64 v28, 0, v25, s[78:79]
  v_cndmask_b32_e64 v29, 0, v25, s[80:81]
  s_nop 1
  v_mfma_f32_16x16x32_bf16 v[8:11], v[26:29], v[180:183], v[8:11]
  v_and_b32_dpp v25, v24, v3 row_newbcast:8 row_mask:0xf bank_mask:0xf
  v_cndmask_b32_e64 v26, 0, v25, s[74:75]
  v_cndmask_b32_e64 v27, 0, v25, s[76:77]
  v_cndmask_b32_e64 v28, 0, v25, s[78:79]
  v_cndmask_b32_e64 v29, 0, v25, s[80:81]
  s_nop 1
  v_mfma_f32_16x16x32_bf16 v[8:11], v[26:29], v[184:187], v[8:11]
  v_and_b32_dpp v25, v24, v3 row_newbcast:12 row_mask:0xf bank_mask:0xf
  v_cndmask_b32_e64 v26, 0, v25, s[74:75]
  v_cndmask_b32_e64 v27, 0, v25, s[76:77]
  v_cndmask_b32_e64 v28, 0, v25, s[78:79]
  v_cndmask_b32_e64 v29, 0, v25, s[80:81]
  s_nop 1
  v_mfma_f32_16x16x32_bf16 v[8:11], v[26:29], v[188:191], v[8:11]
  s_setpc_b64 s[60:61]
L_proc_S3_Y:
  v_cndmask_b32_e64 v26, 0, v14, s[52:53]
  v_cndmask_b32_e64 v27, 0, v15, s[52:53]
  v_cndmask_b32_e64 v28, 0, v16, s[52:53]
  v_cndmask_b32_e64 v29, 0, v17, s[52:53]
  v_mov_b32 v31, s73
  s_nop 0
  v_mfma_f32_16x16x32_bf16 v[22:25], v[160:163], v[26:29], 0
  v_cndmask_b32_e64 v26, 0, v14, s[54:55]
  v_cndmask_b32_e64 v27, 0, v15, s[54:55]
  v_cndmask_b32_e64 v28, 0, v16, s[54:55]
  v_cndmask_b32_e64 v29, 0, v17, s[54:55]
  s_nop 1
  v_mfma_f32_16x16x32_bf16 v[22:25], v[164:167], v[26:29], v[22:25]
  v_cndmask_b32_e64 v26, 0, v14, s[56:57]
  v_cndmask_b32_e64 v27, 0, v15, s[56:57]
  v_cndmask_b32_e64 v28, 0, v16, s[56:57]
  v_cndmask_b32_e64 v29, 0, v17, s[56:57]
  s_nop 1
  v_mfma_f32_16x16x32_bf16 v[22:25], v[168:171], v[26:29], v[22:25]
  v_cndmask_b32_e64 v26, 0, v14, s[58:59]
  v_cndmask_b32_e64 v27, 0, v15, s[58:59]
  v_cndmask_b32_e64 v28, 0, v16, s[58:59]
  v_cndmask_b32_e64 v29, 0, v17, s[58:59]
  s_nop 1
  v_mfma_f32_16x16x32_bf16 v[22:25], v[172:175], v[26:29], v[22:25]
  s_nop 7
  v_mov_b32_dpp v30, v22 quad_perm:[0,0,0,0] row_mask:0xf bank_mask:0xf
  v_add_f32_dpp v30, v23, v30 quad_perm:[1,1,1,1] row_mask:0xf bank_mask:0xf
  v_add_f32_dpp v30, v24, v30 quad_perm:[2,2,2,2] row_mask:0xf bank_mask:0xf
  v_add_f32_dpp v30, v25, v30 quad_perm:[3,3,3,3] row_mask:0xf bank_mask:0xf
  v_mul_f32 v30, s64, v30
  v_max_f32 v23, v30, v31
  s_nop 1
  v_max_f32_dpp v23, v23, v23 row_ror:4 row_mask:0xf bank_mask:0xf
  s_nop 1
  v_max_f32_dpp v23, v23, v23 row_ror:8 row_mask:0xf bank_mask:0xf
  s_nop 1
  v_max_f32_dpp v23, v23, v23 row_bcast:15 row_mask:0xa bank_mask:0xf
  s_nop 1
  v_max_f32_dpp v23, v23, v23 row_bcast:31 row_mask:0xc bank_mask:0xf
  s_nop 0
  v_readlane_b32 s65, v23, 63
  s_nop 1
  v_subrev_f32 v22, s65, v30
  v_subrev_f32 v23, s65, v31
  v_exp_f32 v22, v22
  v_exp_f32 v23, v23
  s_mov_b32 s73, s65
  s_nop 0
  v_cvt_pk_bf16_f32 v24, v22, v22
  v_mul_f32 v18, v23, v18
  v_mul_f32 v19, v23, v19
  v_mul_f32 v20, v23, v20
  v_mul_f32 v21, v23, v21
  v_fma_f32 v13, v13, v23, v22
  v_and_b32_dpp v25, v24, v3 row_newbcast:0 row_mask:0xf bank_mask:0xf
  v_cndmask_b32_e64 v26, 0, v25, s[74:75]
  v_cndmask_b32_e64 v27, 0, v25, s[76:77]
  v_cndmask_b32_e64 v28, 0, v25, s[78:79]
  v_cndmask_b32_e64 v29, 0, v25, s[80:81]
  s_nop 1
  v_mfma_f32_16x16x32_bf16 v[18:21], v[26:29], v[176:179], v[18:21]
  v_and_b32_dpp v25, v24, v3 row_newbcast:4 row_mask:0xf bank_mask:0xf
  v_cndmask_b32_e64 v26, 0, v25, s[74:75]
  v_cndmask_b32_e64 v27, 0, v25, s[76:77]
  v_cndmask_b32_e64 v28, 0, v25, s[78:79]
  v_cndmask_b32_e64 v29, 0, v25, s[80:81]
  s_nop 1
  v_mfma_f32_16x16x32_bf16 v[18:21], v[26:29], v[180:183], v[18:21]
  v_and_b32_dpp v25, v24, v3 row_newbcast:8 row_mask:0xf bank_mask:0xf
  v_cndmask_b32_e64 v26, 0, v25, s[74:75]
  v_cndmask_b32_e64 v27, 0, v25, s[76:77]
  v_cndmask_b32_e64 v28, 0, v25, s[78:79]
  v_cndmask_b32_e64 v29, 0, v25, s[80:81]
  s_nop 1
  v_mfma_f32_16x16x32_bf16 v[18:21], v[26:29], v[184:187], v[18:21]
  v_and_b32_dpp v25, v24, v3 row_newbcast:12 row_mask:0xf bank_mask:0xf
  v_cndmask_b32_e64 v26, 0, v25, s[74:75]
  v_cndmask_b32_e64 v27, 0, v25, s[76:77]
  v_cndmask_b32_e64 v28, 0, v25, s[78:79]
  v_cndmask_b32_e64 v29, 0, v25, s[80:81]
  s_nop 1
  v_mfma_f32_16x16x32_bf16 v[18:21], v[26:29], v[188:191], v[18:21]
  s_setpc_b64 s[60:61]
L_proc_S4_X:
  v_cndmask_b32_e64 v26, 0, v4, s[52:53]
  v_cndmask_b32_e64 v27, 0, v5, s[52:53]
  v_cndmask_b32_e64 v28, 0, v6, s[52:53]
  v_cndmask_b32_e64 v29, 0, v7, s[52:53]
  v_mov_b32 v31, s72
  s_nop 0
  v_mfma_f32_16x16x32_bf16 v[22:25], v[192:195], v[26:29], 0
  v_cndmask_b32_e64 v26, 0, v4, s[54:55]
  v_cndmask_b32_e64 v27, 0, v5, s[54:55]
  v_cndmask_b32_e64 v28, 0, v6, s[54:55]
  v_cndmask_b32_e64 v29, 0, v7, s[54:55]
  s_nop 1
  v_mfma_f32_16x16x32_bf16 v[22:25], v[196:199], v[26:29], v[22:25]
  v_cndmask_b32_e64 v26, 0, v4, s[56:57]
  v_cndmask_b32_e64 v27, 0, v5, s[56:57]
  v_cndmask_b32_e64 v28, 0, v6, s[56:57]
  v_cndmask_b32_e64 v29, 0, v7, s[56:57]
  s_nop 1
  v_mfma_f32_16x16x32_bf16 v[22:25], v[200:203], v[26:29], v[22:25]
  v_cndmask_b32_e64 v26, 0, v4, s[58:59]
  v_cndmask_b32_e64 v27, 0, v5, s[58:59]
  v_cndmask_b32_e64 v28, 0, v6, s[58:59]
  v_cndmask_b32_e64 v29, 0, v7, s[58:59]
  s_nop 1
  v_mfma_f32_16x16x32_bf16 v[22:25], v[204:207], v[26:29], v[22:25]
  s_nop 7
  v_mov_b32_dpp v30, v22 quad_perm:[0,0,0,0] row_mask:0xf bank_mask:0xf
  v_add_f32_dpp v30, v23, v30 quad_perm:[1,1,1,1] row_mask:0xf bank_mask:0xf
  v_add_f32_dpp v30, v24, v30 quad_perm:[2,2,2,2] row_mask:0xf bank_mask:0xf
  v_add_f32_dpp v30, v25, v30 quad_perm:[3,3,3,3] row_mask:0xf bank_mask:0xf
  v_mul_f32 v30, s64, v30
  v_max_f32 v23, v30, v31
  s_nop 1
  v_max_f32_dpp v23, v23, v23 row_ror:4 row_mask:0xf bank_mask:0xf
  s_nop 1
  v_max_f32_dpp v23, v23, v23 row_ror:8 row_mask:0xf bank_mask:0xf
  s_nop 1
  v_max_f32_dpp v23, v23, v23 row_bcast:15 row_mask:0xa bank_mask:0xf
  s_nop 1
  v_max_f32_dpp v23, v23, v23 row_bcast:31 row_mask:0xc bank_mask:0xf
  s_nop 0
  v_readlane_b32 s65, v23, 63
  s_nop 1
  v_subrev_f32 v22, s65, v30
  v_subrev_f32 v23, s65, v31
  v_exp_f32 v22, v22
  v_exp_f32 v23, v23
  s_mov_b32 s72, s65
  s_nop 0
  v_cvt_pk_bf16_f32 v24, v22, v22
  v_mul_f32 v8, v23, v8
  v_mul_f32 v9, v23, v9
  v_mul_f32 v10, v23, v10
  v_mul_f32 v11, v23, v11
  v_fma_f32 v12, v12, v23, v22
  v_and_b32_dpp v25, v24, v3 row_newbcast:0 row_mask:0xf bank_mask:0xf
  v_cndmask_b32_e64 v26, 0, v25, s[74:75]
  v_cndmask_b32_e64 v27, 0, v25, s[76:77]
  v_cndmask_b32_e64 v28, 0, v25, s[78:79]
  v_cndmask_b32_e64 v29, 0, v25, s[80:81]
  s_nop 1
  v_mfma_f32_16x16x32_bf16 v[8:11], v[26:29], v[208:211], v[8:11]
  v_and_b32_dpp v25, v24, v3 row_newbcast:4 row_mask:0xf bank_mask:0xf
  v_cndmask_b32_e64 v26, 0, v25, s[74:75]
  v_cndmask_b32_e64 v27, 0, v25, s[76:77]
  v_cndmask_b32_e64 v28, 0, v25, s[78:79]
  v_cndmask_b32_e64 v29, 0, v25, s[80:81]
  s_nop 1
  v_mfma_f32_16x16x32_bf16 v[8:11], v[26:29], v[212:215], v[8:11]
  v_and_b32_dpp v25, v24, v3 row_newbcast:8 row_mask:0xf bank_mask:0xf
  v_cndmask_b32_e64 v26, 0, v25, s[74:75]
  v_cndmask_b32_e64 v27, 0, v25, s[76:77]
  v_cndmask_b32_e64 v28, 0, v25, s[78:79]
  v_cndmask_b32_e64 v29, 0, v25, s[80:81]
  s_nop 1
  v_mfma_f32_16x16x32_bf16 v[8:11], v[26:29], v[216:219], v[8:11]
  v_and_b32_dpp v25, v24, v3 row_newbcast:12 row_mask:0xf bank_mask:0xf
  v_cndmask_b32_e64 v26, 0, v25, s[74:75]
  v_cndmask_b32_e64 v27, 0, v25, s[76:77]
  v_cndmask_b32_e64 v28, 0, v25, s[78:79]
  v_cndmask_b32_e64 v29, 0, v25, s[80:81]
  s_nop 1
  v_mfma_f32_16x16x32_bf16 v[8:11], v[26:29], v[220:223], v[8:11]
  s_setpc_b64 s[60:61]
L_proc_S4_Y:
  v_cndmask_b32_e64 v26, 0, v14, s[52:53]
  v_cndmask_b32_e64 v27, 0, v15, s[52:53]
  v_cndmask_b32_e64 v28, 0, v16, s[52:53]
  v_cndmask_b32_e64 v29, 0, v17, s[52:53]
  v_mov_b32 v31, s73
  s_nop 0
  v_mfma_f32_16x16x32_bf16 v[22:25], v[192:195], v[26:29], 0
  v_cndmask_b32_e64 v26, 0, v14, s[54:55]
  v_cndmask_b32_e64 v27, 0, v15, s[54:55]
  v_cndmask_b32_e64 v28, 0, v16, s[54:55]
  v_cndmask_b32_e64 v29, 0, v17, s[54:55]
  s_nop 1
  v_mfma_f32_16x16x32_bf16 v[22:25], v[196:199], v[26:29], v[22:25]
  v_cndmask_b32_e64 v26, 0, v14, s[56:57]
  v_cndmask_b32_e64 v27, 0, v15, s[56:57]
  v_cndmask_b32_e64 v28, 0, v16, s[56:57]
  v_cndmask_b32_e64 v29, 0, v17, s[56:57]
  s_nop 1
  v_mfma_f32_16x16x32_bf16 v[22:25], v[200:203], v[26:29], v[22:25]
  v_cndmask_b32_e64 v26, 0, v14, s[58:59]
  v_cndmask_b32_e64 v27, 0, v15, s[58:59]
  v_cndmask_b32_e64 v28, 0, v16, s[58:59]
  v_cndmask_b32_e64 v29, 0, v17, s[58:59]
  s_nop 1
  v_mfma_f32_16x16x32_bf16 v[22:25], v[204:207], v[26:29], v[22:25]
  s_nop 7
  v_mov_b32_dpp v30, v22 quad_perm:[0,0,0,0] row_mask:0xf bank_mask:0xf
  v_add_f32_dpp v30, v23, v30 quad_perm:[1,1,1,1] row_mask:0xf bank_mask:0xf
  v_add_f32_dpp v30, v24, v30 quad_perm:[2,2,2,2] row_mask:0xf bank_mask:0xf
  v_add_f32_dpp v30, v25, v30 quad_perm:[3,3,3,3] row_mask:0xf bank_mask:0xf
  v_mul_f32 v30, s64, v30
  v_max_f32 v23, v30, v31
  s_nop 1
  v_max_f32_dpp v23, v23, v23 row_ror:4 row_mask:0xf bank_mask:0xf
  s_nop 1
  v_max_f32_dpp v23, v23, v23 row_ror:8 row_mask:0xf bank_mask:0xf
  s_nop 1
  v_max_f32_dpp v23, v23, v23 row_bcast:15 row_mask:0xa bank_mask:0xf
  s_nop 1
  v_max_f32_dpp v23, v23, v23 row_bcast:31 row_mask:0xc bank_mask:0xf
  s_nop 0
  v_readlane_b32 s65, v23, 63
  s_nop 1
  v_subrev_f32 v22, s65, v30
  v_subrev_f32 v23, s65, v31
  v_exp_f32 v22, v22
  v_exp_f32 v23, v23
  s_mov_b32 s73, s65
  s_nop 0
  v_cvt_pk_bf16_f32 v24, v22, v22
  v_mul_f32 v18, v23, v18
  v_mul_f32 v19, v23, v19
  v_mul_f32 v20, v23, v20
  v_mul_f32 v21, v23, v21
  v_fma_f32 v13, v13, v23, v22
  v_and_b32_dpp v25, v24, v3 row_newbcast:0 row_mask:0xf bank_mask:0xf
  v_cndmask_b32_e64 v26, 0, v25, s[74:75]
  v_cndmask_b32_e64 v27, 0, v25, s[76:77]
  v_cndmask_b32_e64 v28, 0, v25, s[78:79]
  v_cndmask_b32_e64 v29, 0, v25, s[80:81]
  s_nop 1
  v_mfma_f32_16x16x32_bf16 v[18:21], v[26:29], v[208:211], v[18:21]
  v_and_b32_dpp v25, v24, v3 row_newbcast:4 row_mask:0xf bank_mask:0xf
  v_cndmask_b32_e64 v26, 0, v25, s[74:75]
  v_cndmask_b32_e64 v27, 0, v25, s[76:77]
  v_cndmask_b32_e64 v28, 0, v25, s[78:79]
  v_cndmask_b32_e64 v29, 0, v25, s[80:81]
  s_nop 1
  v_mfma_f32_16x16x32_bf16 v[18:21], v[26:29], v[212:215], v[18:21]
  v_and_b32_dpp v25, v24, v3 row_newbcast:8 row_mask:0xf bank_mask:0xf
  v_cndmask_b32_e64 v26, 0, v25, s[74:75]
  v_cndmask_b32_e64 v27, 0, v25, s[76:77]
  v_cndmask_b32_e64 v28, 0, v25, s[78:79]
  v_cndmask_b32_e64 v29, 0, v25, s[80:81]
  s_nop 1
  v_mfma_f32_16x16x32_bf16 v[18:21], v[26:29], v[216:219], v[18:21]
  v_and_b32_dpp v25, v24, v3 row_newbcast:12 row_mask:0xf bank_mask:0xf
  v_cndmask_b32_e64 v26, 0, v25, s[74:75]
  v_cndmask_b32_e64 v27, 0, v25, s[76:77]
  v_cndmask_b32_e64 v28, 0, v25, s[78:79]
  v_cndmask_b32_e64 v29, 0, v25, s[80:81]
  s_nop 1
  v_mfma_f32_16x16x32_bf16 v[18:21], v[26:29], v[220:223], v[18:21]
  s_setpc_b64 s[60:61]
L_proc_S5_X:
  v_cndmask_b32_e64 v26, 0, v4, s[52:53]
  v_cndmask_b32_e64 v27, 0, v5, s[52:53]
  v_cndmask_b32_e64 v28, 0, v6, s[52:53]
  v_cndmask_b32_e64 v29, 0, v7, s[52:53]
  v_mov_b32 v31, s72
  s_nop 0
  v_mfma_f32_16x16x32_bf16 v[22:25], v[224:227], v[26:29], 0
  v_cndmask_b32_e64 v26, 0, v4, s[54:55]
  v_cndmask_b32_e64 v27, 0, v5, s[54:55]
  v_cndmask_b32_e64 v28, 0, v6, s[54:55]
  v_cndmask_b32_e64 v29, 0, v7, s[54:55]
  s_nop 1
  v_mfma_f32_16x16x32_bf16 v[22:25], v[228:231], v[26:29], v[22:25]
  v_cndmask_b32_e64 v26, 0, v4, s[56:57]
  v_cndmask_b32_e64 v27, 0, v5, s[56:57]
  v_cndmask_b32_e64 v28, 0, v6, s[56:57]
  v_cndmask_b32_e64 v29, 0, v7, s[56:57]
  s_nop 1
  v_mfma_f32_16x16x32_bf16 v[22:25], v[232:235], v[26:29], v[22:25]
  v_cndmask_b32_e64 v26, 0, v4, s[58:59]
  v_cndmask_b32_e64 v27, 0, v5, s[58:59]
  v_cndmask_b32_e64 v28, 0, v6, s[58:59]
  v_cndmask_b32_e64 v29, 0, v7, s[58:59]
  s_nop 1
  v_mfma_f32_16x16x32_bf16 v[22:25], v[236:239], v[26:29], v[22:25]
  s_nop 7
  v_mov_b32_dpp v30, v22 quad_perm:[0,0,0,0] row_mask:0xf bank_mask:0xf
  v_add_f32_dpp v30, v23, v30 quad_perm:[1,1,1,1] row_mask:0xf bank_mask:0xf
  v_add_f32_dpp v30, v24, v30 quad_perm:[2,2,2,2] row_mask:0xf bank_mask:0xf
  v_add_f32_dpp v30, v25, v30 quad_perm:[3,3,3,3] row_mask:0xf bank_mask:0xf
  v_mul_f32 v30, s64, v30
  v_max_f32 v23, v30, v31
  s_nop 1
  v_max_f32_dpp v23, v23, v23 row_ror:4 row_mask:0xf bank_mask:0xf
  s_nop 1
  v_max_f32_dpp v23, v23, v23 row_ror:8 row_mask:0xf bank_mask:0xf
  s_nop 1
  v_max_f32_dpp v23, v23, v23 row_bcast:15 row_mask:0xa bank_mask:0xf
  s_nop 1
  v_max_f32_dpp v23, v23, v23 row_bcast:31 row_mask:0xc bank_mask:0xf
  s_nop 0
  v_readlane_b32 s65, v23, 63
  s_nop 1
  v_subrev_f32 v22, s65, v30
  v_subrev_f32 v23, s65, v31
  v_exp_f32 v22, v22
  v_exp_f32 v23, v23
  s_mov_b32 s72, s65
  s_nop 0
  v_cvt_pk_bf16_f32 v24, v22, v22
  v_mul_f32 v8, v23, v8
  v_mul_f32 v9, v23, v9
  v_mul_f32 v10, v23, v10
  v_mul_f32 v11, v23, v11
  v_fma_f32 v12, v12, v23, v22
  v_and_b32_dpp v25, v24, v3 row_newbcast:0 row_mask:0xf bank_mask:0xf
  v_cndmask_b32_e64 v26, 0, v25, s[74:75]
  v_cndmask_b32_e64 v27, 0, v25, s[76:77]
  v_cndmask_b32_e64 v28, 0, v25, s[78:79]
  v_cndmask_b32_e64 v29, 0, v25, s[80:81]
  s_nop 1
  v_mfma_f32_16x16x32_bf16 v[8:11], v[26:29], v[240:243], v[8:11]
  v_and_b32_dpp v25, v24, v3 row_newbcast:4 row_mask:0xf bank_mask:0xf
  v_cndmask_b32_e64 v26, 0, v25, s[74:75]
  v_cndmask_b32_e64 v27, 0, v25, s[76:77]
  v_cndmask_b32_e64 v28, 0, v25, s[78:79]
  v_cndmask_b32_e64 v29, 0, v25, s[80:81]
  s_nop 1
  v_mfma_f32_16x16x32_bf16 v[8:11], v[26:29], v[244:247], v[8:11]
  v_and_b32_dpp v25, v24, v3 row_newbcast:8 row_mask:0xf bank_mask:0xf
  v_cndmask_b32_e64 v26, 0, v25, s[74:75]
  v_cndmask_b32_e64 v27, 0, v25, s[76:77]
  v_cndmask_b32_e64 v28, 0, v25, s[78:79]
  v_cndmask_b32_e64 v29, 0, v25, s[80:81]
  s_nop 1
  v_mfma_f32_16x16x32_bf16 v[8:11], v[26:29], v[248:251], v[8:11]
  v_and_b32_dpp v25, v24, v3 row_newbcast:12 row_mask:0xf bank_mask:0xf
  v_cndmask_b32_e64 v26, 0, v25, s[74:75]
  v_cndmask_b32_e64 v27, 0, v25, s[76:77]
  v_cndmask_b32_e64 v28, 0, v25, s[78:79]
  v_cndmask_b32_e64 v29, 0, v25, s[80:81]
  s_nop 1
  v_mfma_f32_16x16x32_bf16 v[8:11], v[26:29], v[252:255], v[8:11]
  s_setpc_b64 s[60:61]
L_proc_S5_Y:
  v_cndmask_b32_e64 v26, 0, v14, s[52:53]
  v_cndmask_b32_e64 v27, 0, v15, s[52:53]
  v_cndmask_b32_e64 v28, 0, v16, s[52:53]
  v_cndmask_b32_e64 v29, 0, v17, s[52:53]
  v_mov_b32 v31, s73
  s_nop 0
  v_mfma_f32_16x16x32_bf16 v[22:25], v[224:227], v[26:29], 0
  v_cndmask_b32_e64 v26, 0, v14, s[54:55]
  v_cndmask_b32_e64 v27, 0, v15, s[54:55]
  v_cndmask_b32_e64 v28, 0, v16, s[54:55]
  v_cndmask_b32_e64 v29, 0, v17, s[54:55]
  s_nop 1
  v_mfma_f32_16x16x32_bf16 v[22:25], v[228:231], v[26:29], v[22:25]
  v_cndmask_b32_e64 v26, 0, v14, s[56:57]
  v_cndmask_b32_e64 v27, 0, v15, s[56:57]
  v_cndmask_b32_e64 v28, 0, v16, s[56:57]
  v_cndmask_b32_e64 v29, 0, v17, s[56:57]
  s_nop 1
  v_mfma_f32_16x16x32_bf16 v[22:25], v[232:235], v[26:29], v[22:25]
  v_cndmask_b32_e64 v26, 0, v14, s[58:59]
  v_cndmask_b32_e64 v27, 0, v15, s[58:59]
  v_cndmask_b32_e64 v28, 0, v16, s[58:59]
  v_cndmask_b32_e64 v29, 0, v17, s[58:59]
  s_nop 1
  v_mfma_f32_16x16x32_bf16 v[22:25], v[236:239], v[26:29], v[22:25]
  s_nop 7
  v_mov_b32_dpp v30, v22 quad_perm:[0,0,0,0] row_mask:0xf bank_mask:0xf
  v_add_f32_dpp v30, v23, v30 quad_perm:[1,1,1,1] row_mask:0xf bank_mask:0xf
  v_add_f32_dpp v30, v24, v30 quad_perm:[2,2,2,2] row_mask:0xf bank_mask:0xf
  v_add_f32_dpp v30, v25, v30 quad_perm:[3,3,3,3] row_mask:0xf bank_mask:0xf
  v_mul_f32 v30, s64, v30
  v_max_f32 v23, v30, v31
  s_nop 1
  v_max_f32_dpp v23, v23, v23 row_ror:4 row_mask:0xf bank_mask:0xf
  s_nop 1
  v_max_f32_dpp v23, v23, v23 row_ror:8 row_mask:0xf bank_mask:0xf
  s_nop 1
  v_max_f32_dpp v23, v23, v23 row_bcast:15 row_mask:0xa bank_mask:0xf
  s_nop 1
  v_max_f32_dpp v23, v23, v23 row_bcast:31 row_mask:0xc bank_mask:0xf
  s_nop 0
  v_readlane_b32 s65, v23, 63
  s_nop 1
  v_subrev_f32 v22, s65, v30
  v_subrev_f32 v23, s65, v31
  v_exp_f32 v22, v22
  v_exp_f32 v23, v23
  s_mov_b32 s73, s65
  s_nop 0
  v_cvt_pk_bf16_f32 v24, v22, v22
  v_mul_f32 v18, v23, v18
  v_mul_f32 v19, v23, v19
  v_mul_f32 v20, v23, v20
  v_mul_f32 v21, v23, v21
  v_fma_f32 v13, v13, v23, v22
  v_and_b32_dpp v25, v24, v3 row_newbcast:0 row_mask:0xf bank_mask:0xf
  v_cndmask_b32_e64 v26, 0, v25, s[74:75]
  v_cndmask_b32_e64 v27, 0, v25, s[76:77]
  v_cndmask_b32_e64 v28, 0, v25, s[78:79]
  v_cndmask_b32_e64 v29, 0, v25, s[80:81]
  s_nop 1
  v_mfma_f32_16x16x32_bf16 v[18:21], v[26:29], v[240:243], v[18:21]
  v_and_b32_dpp v25, v24, v3 row_newbcast:4 row_mask:0xf bank_mask:0xf
  v_cndmask_b32_e64 v26, 0, v25, s[74:75]
  v_cndmask_b32_e64 v27, 0, v25, s[76:77]
  v_cndmask_b32_e64 v28, 0, v25, s[78:79]
  v_cndmask_b32_e64 v29, 0, v25, s[80:81]
  s_nop 1
  v_mfma_f32_16x16x32_bf16 v[18:21], v[26:29], v[244:247], v[18:21]
  v_and_b32_dpp v25, v24, v3 row_newbcast:8 row_mask:0xf bank_mask:0xf
  v_cndmask_b32_e64 v26, 0, v25, s[74:75]
  v_cndmask_b32_e64 v27, 0, v25, s[76:77]
  v_cndmask_b32_e64 v28, 0, v25, s[78:79]
  v_cndmask_b32_e64 v29, 0, v25, s[80:81]
  s_nop 1
  v_mfma_f32_16x16x32_bf16 v[18:21], v[26:29], v[248:251], v[18:21]
  v_and_b32_dpp v25, v24, v3 row_newbcast:12 row_mask:0xf bank_mask:0xf
  v_cndmask_b32_e64 v26, 0, v25, s[74:75]
  v_cndmask_b32_e64 v27, 0, v25, s[76:77]
  v_cndmask_b32_e64 v28, 0, v25, s[78:79]
  v_cndmask_b32_e64 v29, 0, v25, s[80:81]
  s_nop 1
  v_mfma_f32_16x16x32_bf16 v[18:21], v[26:29], v[252:255], v[18:21]
  s_setpc_b64 s[60:61]
L_proc_S6_X:
  v_cndmask_b32_e64 v26, 0, v4, s[52:53]
  v_cndmask_b32_e64 v27, 0, v5, s[52:53]
  v_cndmask_b32_e64 v28, 0, v6, s[52:53]
  v_cndmask_b32_e64 v29, 0, v7, s[52:53]
  v_mov_b32 v31, s72
  s_nop 0
  v_mfma_f32_16x16x32_bf16 v[22:25], a[0:3], v[26:29], 0
  v_cndmask_b32_e64 v26, 0, v4, s[54:55]
  v_cndmask_b32_e64 v27, 0, v5, s[54:55]
  v_cndmask_b32_e64 v28, 0, v6, s[54:55]
  v_cndmask_b32_e64 v29, 0, v7, s[54:55]
  s_nop 1
  v_mfma_f32_16x16x32_bf16 v[22:25], a[4:7], v[26:29], v[22:25]
  v_cndmask_b32_e64 v26, 0, v4, s[56:57]
  v_cndmask_b32_e64 v27, 0, v5, s[56:57]
  v_cndmask_b32_e64 v28, 0, v6, s[56:57]
  v_cndmask_b32_e64 v29, 0, v7, s[56:57]
  s_nop 1
  v_mfma_f32_16x16x32_bf16 v[22:25], a[8:11], v[26:29], v[22:25]
  v_cndmask_b32_e64 v26, 0, v4, s[58:59]
  v_cndmask_b32_e64 v27, 0, v5, s[58:59]
  v_cndmask_b32_e64 v28, 0, v6, s[58:59]
  v_cndmask_b32_e64 v29, 0, v7, s[58:59]
  s_nop 1
  v_mfma_f32_16x16x32_bf16 v[22:25], a[12:15], v[26:29], v[22:25]
  s_nop 7
  v_mov_b32_dpp v30, v22 quad_perm:[0,0,0,0] row_mask:0xf bank_mask:0xf
  v_add_f32_dpp v30, v23, v30 quad_perm:[1,1,1,1] row_mask:0xf bank_mask:0xf
  v_add_f32_dpp v30, v24, v30 quad_perm:[2,2,2,2] row_mask:0xf bank_mask:0xf
  v_add_f32_dpp v30, v25, v30 quad_perm:[3,3,3,3] row_mask:0xf bank_mask:0xf
  v_mul_f32 v30, s64, v30
  v_max_f32 v23, v30, v31
  s_nop 1
  v_max_f32_dpp v23, v23, v23 row_ror:4 row_mask:0xf bank_mask:0xf
  s_nop 1
  v_max_f32_dpp v23, v23, v23 row_ror:8 row_mask:0xf bank_mask:0xf
  s_nop 1
  v_max_f32_dpp v23, v23, v23 row_bcast:15 row_mask:0xa bank_mask:0xf
  s_nop 1
  v_max_f32_dpp v23, v23, v23 row_bcast:31 row_mask:0xc bank_mask:0xf
  s_nop 0
  v_readlane_b32 s65, v23, 63
  s_nop 1
  v_subrev_f32 v22, s65, v30
  v_subrev_f32 v23, s65, v31
  v_exp_f32 v22, v22
  v_exp_f32 v23, v23
  s_mov_b32 s72, s65
  s_nop 0
  v_cvt_pk_bf16_f32 v24, v22, v22
  v_mul_f32 v8, v23, v8
  v_mul_f32 v9, v23, v9
  v_mul_f32 v10, v23, v10
  v_mul_f32 v11, v23, v11
  v_fma_f32 v12, v12, v23, v22
  v_and_b32_dpp v25, v24, v3 row_newbcast:0 row_mask:0xf bank_mask:0xf
  v_cndmask_b32_e64 v26, 0, v25, s[74:75]
  v_cndmask_b32_e64 v27, 0, v25, s[76:77]
  v_cndmask_b32_e64 v28, 0, v25, s[78:79]
  v_cndmask_b32_e64 v29, 0, v25, s[80:81]
  s_nop 1
  v_mfma_f32_16x16x32_bf16 v[8:11], v[26:29], a[16:19], v[8:11]
  v_and_b32_dpp v25, v24, v3 row_newbcast:4 row_mask:0xf bank_mask:0xf
  v_cndmask_b32_e64 v26, 0, v25, s[74:75]
  v_cndmask_b32_e64 v27, 0, v25, s[76:77]
  v_cndmask_b32_e64 v28, 0, v25, s[78:79]
  v_cndmask_b32_e64 v29, 0, v25, s[80:81]
  s_nop 1
  v_mfma_f32_16x16x32_bf16 v[8:11], v[26:29], a[20:23], v[8:11]
  v_and_b32_dpp v25, v24, v3 row_newbcast:8 row_mask:0xf bank_mask:0xf
  v_cndmask_b32_e64 v26, 0, v25, s[74:75]
  v_cndmask_b32_e64 v27, 0, v25, s[76:77]
  v_cndmask_b32_e64 v28, 0, v25, s[78:79]
  v_cndmask_b32_e64 v29, 0, v25, s[80:81]
  s_nop 1
  v_mfma_f32_16x16x32_bf16 v[8:11], v[26:29], a[24:27], v[8:11]
  v_and_b32_dpp v25, v24, v3 row_newbcast:12 row_mask:0xf bank_mask:0xf
  v_cndmask_b32_e64 v26, 0, v25, s[74:75]
  v_cndmask_b32_e64 v27, 0, v25, s[76:77]
  v_cndmask_b32_e64 v28, 0, v25, s[78:79]
  v_cndmask_b32_e64 v29, 0, v25, s[80:81]
  s_nop 1
  v_mfma_f32_16x16x32_bf16 v[8:11], v[26:29], a[28:31], v[8:11]
  s_setpc_b64 s[60:61]
L_proc_S6_Y:
  v_cndmask_b32_e64 v26, 0, v14, s[52:53]
  v_cndmask_b32_e64 v27, 0, v15, s[52:53]
  v_cndmask_b32_e64 v28, 0, v16, s[52:53]
  v_cndmask_b32_e64 v29, 0, v17, s[52:53]
  v_mov_b32 v31, s73
  s_nop 0
  v_mfma_f32_16x16x32_bf16 v[22:25], a[0:3], v[26:29], 0
  v_cndmask_b32_e64 v26, 0, v14, s[54:55]
  v_cndmask_b32_e64 v27, 0, v15, s[54:55]
  v_cndmask_b32_e64 v28, 0, v16, s[54:55]
  v_cndmask_b32_e64 v29, 0, v17, s[54:55]
  s_nop 1
  v_mfma_f32_16x16x32_bf16 v[22:25], a[4:7], v[26:29], v[22:25]
  v_cndmask_b32_e64 v26, 0, v14, s[56:57]
  v_cndmask_b32_e64 v27, 0, v15, s[56:57]
  v_cndmask_b32_e64 v28, 0, v16, s[56:57]
  v_cndmask_b32_e64 v29, 0, v17, s[56:57]
  s_nop 1
  v_mfma_f32_16x16x32_bf16 v[22:25], a[8:11], v[26:29], v[22:25]
  v_cndmask_b32_e64 v26, 0, v14, s[58:59]
  v_cndmask_b32_e64 v27, 0, v15, s[58:59]
  v_cndmask_b32_e64 v28, 0, v16, s[58:59]
  v_cndmask_b32_e64 v29, 0, v17, s[58:59]
  s_nop 1
  v_mfma_f32_16x16x32_bf16 v[22:25], a[12:15], v[26:29], v[22:25]
  s_nop 7
  v_mov_b32_dpp v30, v22 quad_perm:[0,0,0,0] row_mask:0xf bank_mask:0xf
  v_add_f32_dpp v30, v23, v30 quad_perm:[1,1,1,1] row_mask:0xf bank_mask:0xf
  v_add_f32_dpp v30, v24, v30 quad_perm:[2,2,2,2] row_mask:0xf bank_mask:0xf
  v_add_f32_dpp v30, v25, v30 quad_perm:[3,3,3,3] row_mask:0xf bank_mask:0xf
  v_mul_f32 v30, s64, v30
  v_max_f32 v23, v30, v31
  s_nop 1
  v_max_f32_dpp v23, v23, v23 row_ror:4 row_mask:0xf bank_mask:0xf
  s_nop 1
  v_max_f32_dpp v23, v23, v23 row_ror:8 row_mask:0xf bank_mask:0xf
  s_nop 1
  v_max_f32_dpp v23, v23, v23 row_bcast:15 row_mask:0xa bank_mask:0xf
  s_nop 1
  v_max_f32_dpp v23, v23, v23 row_bcast:31 row_mask:0xc bank_mask:0xf
  s_nop 0
  v_readlane_b32 s65, v23, 63
  s_nop 1
  v_subrev_f32 v22, s65, v30
  v_subrev_f32 v23, s65, v31
  v_exp_f32 v22, v22
  v_exp_f32 v23, v23
  s_mov_b32 s73, s65
  s_nop 0
  v_cvt_pk_bf16_f32 v24, v22, v22
  v_mul_f32 v18, v23, v18
  v_mul_f32 v19, v23, v19
  v_mul_f32 v20, v23, v20
  v_mul_f32 v21, v23, v21
  v_fma_f32 v13, v13, v23, v22
  v_and_b32_dpp v25, v24, v3 row_newbcast:0 row_mask:0xf bank_mask:0xf
  v_cndmask_b32_e64 v26, 0, v25, s[74:75]
  v_cndmask_b32_e64 v27, 0, v25, s[76:77]
  v_cndmask_b32_e64 v28, 0, v25, s[78:79]
  v_cndmask_b32_e64 v29, 0, v25, s[80:81]
  s_nop 1
  v_mfma_f32_16x16x32_bf16 v[18:21], v[26:29], a[16:19], v[18:21]
  v_and_b32_dpp v25, v24, v3 row_newbcast:4 row_mask:0xf bank_mask:0xf
  v_cndmask_b32_e64 v26, 0, v25, s[74:75]
  v_cndmask_b32_e64 v27, 0, v25, s[76:77]
  v_cndmask_b32_e64 v28, 0, v25, s[78:79]
  v_cndmask_b32_e64 v29, 0, v25, s[80:81]
  s_nop 1
  v_mfma_f32_16x16x32_bf16 v[18:21], v[26:29], a[20:23], v[18:21]
  v_and_b32_dpp v25, v24, v3 row_newbcast:8 row_mask:0xf bank_mask:0xf
  v_cndmask_b32_e64 v26, 0, v25, s[74:75]
  v_cndmask_b32_e64 v27, 0, v25, s[76:77]
  v_cndmask_b32_e64 v28, 0, v25, s[78:79]
  v_cndmask_b32_e64 v29, 0, v25, s[80:81]
  s_nop 1
  v_mfma_f32_16x16x32_bf16 v[18:21], v[26:29], a[24:27], v[18:21]
  v_and_b32_dpp v25, v24, v3 row_newbcast:12 row_mask:0xf bank_mask:0xf
  v_cndmask_b32_e64 v26, 0, v25, s[74:75]
  v_cndmask_b32_e64 v27, 0, v25, s[76:77]
  v_cndmask_b32_e64 v28, 0, v25, s[78:79]
  v_cndmask_b32_e64 v29, 0, v25, s[80:81]
  s_nop 1
  v_mfma_f32_16x16x32_bf16 v[18:21], v[26:29], a[28:31], v[18:21]
  s_setpc_b64 s[60:61]
L_proc_S7_X:
  v_cndmask_b32_e64 v26, 0, v4, s[52:53]
  v_cndmask_b32_e64 v27, 0, v5, s[52:53]
  v_cndmask_b32_e64 v28, 0, v6, s[52:53]
  v_cndmask_b32_e64 v29, 0, v7, s[52:53]
  v_mov_b32 v31, s72
  s_nop 0
  v_mfma_f32_16x16x32_bf16 v[22:25], a[32:35], v[26:29], 0
  v_cndmask_b32_e64 v26, 0, v4, s[54:55]
  v_cndmask_b32_e64 v27, 0, v5, s[54:55]
  v_cndmask_b32_e64 v28, 0, v6, s[54:55]
  v_cndmask_b32_e64 v29, 0, v7, s[54:55]
  s_nop 1
  v_mfma_f32_16x16x32_bf16 v[22:25], a[36:39], v[26:29], v[22:25]
  v_cndmask_b32_e64 v26, 0, v4, s[56:57]
  v_cndmask_b32_e64 v27, 0, v5, s[56:57]
  v_cndmask_b32_e64 v28, 0, v6, s[56:57]
  v_cndmask_b32_e64 v29, 0, v7, s[56:57]
  s_nop 1
  v_mfma_f32_16x16x32_bf16 v[22:25], a[40:43], v[26:29], v[22:25]
  v_cndmask_b32_e64 v26, 0, v4, s[58:59]
  v_cndmask_b32_e64 v27, 0, v5, s[58:59]
  v_cndmask_b32_e64 v28, 0, v6, s[58:59]
  v_cndmask_b32_e64 v29, 0, v7, s[58:59]
  s_nop 1
  v_mfma_f32_16x16x32_bf16 v[22:25], a[44:47], v[26:29], v[22:25]
  s_nop 7
  v_mov_b32_dpp v30, v22 quad_perm:[0,0,0,0] row_mask:0xf bank_mask:0xf
  v_add_f32_dpp v30, v23, v30 quad_perm:[1,1,1,1] row_mask:0xf bank_mask:0xf
  v_add_f32_dpp v30, v24, v30 quad_perm:[2,2,2,2] row_mask:0xf bank_mask:0xf
  v_add_f32_dpp v30, v25, v30 quad_perm:[3,3,3,3] row_mask:0xf bank_mask:0xf
  v_mul_f32 v30, s64, v30
  v_max_f32 v23, v30, v31
  s_nop 1
  v_max_f32_dpp v23, v23, v23 row_ror:4 row_mask:0xf bank_mask:0xf
  s_nop 1
  v_max_f32_dpp v23, v23, v23 row_ror:8 row_mask:0xf bank_mask:0xf
  s_nop 1
  v_max_f32_dpp v23, v23, v23 row_bcast:15 row_mask:0xa bank_mask:0xf
  s_nop 1
  v_max_f32_dpp v23, v23, v23 row_bcast:31 row_mask:0xc bank_mask:0xf
  s_nop 0
  v_readlane_b32 s65, v23, 63
  s_nop 1
  v_subrev_f32 v22, s65, v30
  v_subrev_f32 v23, s65, v31
  v_exp_f32 v22, v22
  v_exp_f32 v23, v23
  s_mov_b32 s72, s65
  s_nop 0
  v_cvt_pk_bf16_f32 v24, v22, v22
  v_mul_f32 v8, v23, v8
  v_mul_f32 v9, v23, v9
  v_mul_f32 v10, v23, v10
  v_mul_f32 v11, v23, v11
  v_fma_f32 v12, v12, v23, v22
  v_and_b32_dpp v25, v24, v3 row_newbcast:0 row_mask:0xf bank_mask:0xf
  v_cndmask_b32_e64 v26, 0, v25, s[74:75]
  v_cndmask_b32_e64 v27, 0, v25, s[76:77]
  v_cndmask_b32_e64 v28, 0, v25, s[78:79]
  v_cndmask_b32_e64 v29, 0, v25, s[80:81]
  s_nop 1
  v_mfma_f32_16x16x32_bf16 v[8:11], v[26:29], a[48:51], v[8:11]
  v_and_b32_dpp v25, v24, v3 row_newbcast:4 row_mask:0xf bank_mask:0xf
  v_cndmask_b32_e64 v26, 0, v25, s[74:75]
  v_cndmask_b32_e64 v27, 0, v25, s[76:77]
  v_cndmask_b32_e64 v28, 0, v25, s[78:79]
  v_cndmask_b32_e64 v29, 0, v25, s[80:81]
  s_nop 1
  v_mfma_f32_16x16x32_bf16 v[8:11], v[26:29], a[52:55], v[8:11]
  v_and_b32_dpp v25, v24, v3 row_newbcast:8 row_mask:0xf bank_mask:0xf
  v_cndmask_b32_e64 v26, 0, v25, s[74:75]
  v_cndmask_b32_e64 v27, 0, v25, s[76:77]
  v_cndmask_b32_e64 v28, 0, v25, s[78:79]
  v_cndmask_b32_e64 v29, 0, v25, s[80:81]
  s_nop 1
  v_mfma_f32_16x16x32_bf16 v[8:11], v[26:29], a[56:59], v[8:11]
  v_and_b32_dpp v25, v24, v3 row_newbcast:12 row_mask:0xf bank_mask:0xf
  v_cndmask_b32_e64 v26, 0, v25, s[74:75]
  v_cndmask_b32_e64 v27, 0, v25, s[76:77]
  v_cndmask_b32_e64 v28, 0, v25, s[78:79]
  v_cndmask_b32_e64 v29, 0, v25, s[80:81]
  s_nop 1
  v_mfma_f32_16x16x32_bf16 v[8:11], v[26:29], a[60:63], v[8:11]
  s_setpc_b64 s[60:61]
L_proc_S7_Y:
  v_cndmask_b32_e64 v26, 0, v14, s[52:53]
  v_cndmask_b32_e64 v27, 0, v15, s[52:53]
  v_cndmask_b32_e64 v28, 0, v16, s[52:53]
  v_cndmask_b32_e64 v29, 0, v17, s[52:53]
  v_mov_b32 v31, s73
  s_nop 0
  v_mfma_f32_16x16x32_bf16 v[22:25], a[32:35], v[26:29], 0
  v_cndmask_b32_e64 v26, 0, v14, s[54:55]
  v_cndmask_b32_e64 v27, 0, v15, s[54:55]
  v_cndmask_b32_e64 v28, 0, v16, s[54:55]
  v_cndmask_b32_e64 v29, 0, v17, s[54:55]
  s_nop 1
  v_mfma_f32_16x16x32_bf16 v[22:25], a[36:39], v[26:29], v[22:25]
  v_cndmask_b32_e64 v26, 0, v14, s[56:57]
  v_cndmask_b32_e64 v27, 0, v15, s[56:57]
  v_cndmask_b32_e64 v28, 0, v16, s[56:57]
  v_cndmask_b32_e64 v29, 0, v17, s[56:57]
  s_nop 1
  v_mfma_f32_16x16x32_bf16 v[22:25], a[40:43], v[26:29], v[22:25]
  v_cndmask_b32_e64 v26, 0, v14, s[58:59]
  v_cndmask_b32_e64 v27, 0, v15, s[58:59]
  v_cndmask_b32_e64 v28, 0, v16, s[58:59]
  v_cndmask_b32_e64 v29, 0, v17, s[58:59]
  s_nop 1
  v_mfma_f32_16x16x32_bf16 v[22:25], a[44:47], v[26:29], v[22:25]
  s_nop 7
  v_mov_b32_dpp v30, v22 quad_perm:[0,0,0,0] row_mask:0xf bank_mask:0xf
  v_add_f32_dpp v30, v23, v30 quad_perm:[1,1,1,1] row_mask:0xf bank_mask:0xf
  v_add_f32_dpp v30, v24, v30 quad_perm:[2,2,2,2] row_mask:0xf bank_mask:0xf
  v_add_f32_dpp v30, v25, v30 quad_perm:[3,3,3,3] row_mask:0xf bank_mask:0xf
  v_mul_f32 v30, s64, v30
  v_max_f32 v23, v30, v31
  s_nop 1
  v_max_f32_dpp v23, v23, v23 row_ror:4 row_mask:0xf bank_mask:0xf
  s_nop 1
  v_max_f32_dpp v23, v23, v23 row_ror:8 row_mask:0xf bank_mask:0xf
  s_nop 1
  v_max_f32_dpp v23, v23, v23 row_bcast:15 row_mask:0xa bank_mask:0xf
  s_nop 1
  v_max_f32_dpp v23, v23, v23 row_bcast:31 row_mask:0xc bank_mask:0xf
  s_nop 0
  v_readlane_b32 s65, v23, 63
  s_nop 1
  v_subrev_f32 v22, s65, v30
  v_subrev_f32 v23, s65, v31
  v_exp_f32 v22, v22
  v_exp_f32 v23, v23
  s_mov_b32 s73, s65
  s_nop 0
  v_cvt_pk_bf16_f32 v24, v22, v22
  v_mul_f32 v18, v23, v18
  v_mul_f32 v19, v23, v19
  v_mul_f32 v20, v23, v20
  v_mul_f32 v21, v23, v21
  v_fma_f32 v13, v13, v23, v22
  v_and_b32_dpp v25, v24, v3 row_newbcast:0 row_mask:0xf bank_mask:0xf
  v_cndmask_b32_e64 v26, 0, v25, s[74:75]
  v_cndmask_b32_e64 v27, 0, v25, s[76:77]
  v_cndmask_b32_e64 v28, 0, v25, s[78:79]
  v_cndmask_b32_e64 v29, 0, v25, s[80:81]
  s_nop 1
  v_mfma_f32_16x16x32_bf16 v[18:21], v[26:29], a[48:51], v[18:21]
  v_and_b32_dpp v25, v24, v3 row_newbcast:4 row_mask:0xf bank_mask:0xf
  v_cndmask_b32_e64 v26, 0, v25, s[74:75]
  v_cndmask_b32_e64 v27, 0, v25, s[76:77]
  v_cndmask_b32_e64 v28, 0, v25, s[78:79]
  v_cndmask_b32_e64 v29, 0, v25, s[80:81]
  s_nop 1
  v_mfma_f32_16x16x32_bf16 v[18:21], v[26:29], a[52:55], v[18:21]
  v_and_b32_dpp v25, v24, v3 row_newbcast:8 row_mask:0xf bank_mask:0xf
  v_cndmask_b32_e64 v26, 0, v25, s[74:75]
  v_cndmask_b32_e64 v27, 0, v25, s[76:77]
  v_cndmask_b32_e64 v28, 0, v25, s[78:79]
  v_cndmask_b32_e64 v29, 0, v25, s[80:81]
  s_nop 1
  v_mfma_f32_16x16x32_bf16 v[18:21], v[26:29], a[56:59], v[18:21]
  v_and_b32_dpp v25, v24, v3 row_newbcast:12 row_mask:0xf bank_mask:0xf
  v_cndmask_b32_e64 v26, 0, v25, s[74:75]
  v_cndmask_b32_e64 v27, 0, v25, s[76:77]
  v_cndmask_b32_e64 v28, 0, v25, s[78:79]
  v_cndmask_b32_e64 v29, 0, v25, s[80:81]
  s_nop 1
  v_mfma_f32_16x16x32_bf16 v[18:21], v[26:29], a[60:63], v[18:21]
  s_setpc_b64 s[60:61]
L_proc_S8_X:
  v_cndmask_b32_e64 v26, 0, v4, s[52:53]
  v_cndmask_b32_e64 v27, 0, v5, s[52:53]
  v_cndmask_b32_e64 v28, 0, v6, s[52:53]
  v_cndmask_b32_e64 v29, 0, v7, s[52:53]
  v_mov_b32 v31, s72
  s_nop 0
  v_mfma_f32_16x16x32_bf16 v[22:25], a[64:67], v[26:29], 0
  v_cndmask_b32_e64 v26, 0, v4, s[54:55]
  v_cndmask_b32_e64 v27, 0, v5, s[54:55]
  v_cndmask_b32_e64 v28, 0, v6, s[54:55]
  v_cndmask_b32_e64 v29, 0, v7, s[54:55]
  s_nop 1
  v_mfma_f32_16x16x32_bf16 v[22:25], a[68:71], v[26:29], v[22:25]
  v_cndmask_b32_e64 v26, 0, v4, s[56:57]
  v_cndmask_b32_e64 v27, 0, v5, s[56:57]
  v_cndmask_b32_e64 v28, 0, v6, s[56:57]
  v_cndmask_b32_e64 v29, 0, v7, s[56:57]
  s_nop 1
  v_mfma_f32_16x16x32_bf16 v[22:25], a[72:75], v[26:29], v[22:25]
  v_cndmask_b32_e64 v26, 0, v4, s[58:59]
  v_cndmask_b32_e64 v27, 0, v5, s[58:59]
  v_cndmask_b32_e64 v28, 0, v6, s[58:59]
  v_cndmask_b32_e64 v29, 0, v7, s[58:59]
  s_nop 1
  v_mfma_f32_16x16x32_bf16 v[22:25], a[76:79], v[26:29], v[22:25]
  s_nop 7
  v_mov_b32_dpp v30, v22 quad_perm:[0,0,0,0] row_mask:0xf bank_mask:0xf
  v_add_f32_dpp v30, v23, v30 quad_perm:[1,1,1,1] row_mask:0xf bank_mask:0xf
  v_add_f32_dpp v30, v24, v30 quad_perm:[2,2,2,2] row_mask:0xf bank_mask:0xf
  v_add_f32_dpp v30, v25, v30 quad_perm:[3,3,3,3] row_mask:0xf bank_mask:0xf
  v_mul_f32 v30, s64, v30
  v_max_f32 v23, v30, v31
  s_nop 1
  v_max_f32_dpp v23, v23, v23 row_ror:4 row_mask:0xf bank_mask:0xf
  s_nop 1
  v_max_f32_dpp v23, v23, v23 row_ror:8 row_mask:0xf bank_mask:0xf
  s_nop 1
  v_max_f32_dpp v23, v23, v23 row_bcast:15 row_mask:0xa bank_mask:0xf
  s_nop 1
  v_max_f32_dpp v23, v23, v23 row_bcast:31 row_mask:0xc bank_mask:0xf
  s_nop 0
  v_readlane_b32 s65, v23, 63
  s_nop 1
  v_subrev_f32 v22, s65, v30
  v_subrev_f32 v23, s65, v31
  v_exp_f32 v22, v22
  v_exp_f32 v23, v23
  s_mov_b32 s72, s65
  s_nop 0
  v_cvt_pk_bf16_f32 v24, v22, v22
  v_mul_f32 v8, v23, v8
  v_mul_f32 v9, v23, v9
  v_mul_f32 v10, v23, v10
  v_mul_f32 v11, v23, v11
  v_fma_f32 v12, v12, v23, v22
  v_and_b32_dpp v25, v24, v3 row_newbcast:0 row_mask:0xf bank_mask:0xf
  v_cndmask_b32_e64 v26, 0, v25, s[74:75]
  v_cndmask_b32_e64 v27, 0, v25, s[76:77]
  v_cndmask_b32_e64 v28, 0, v25, s[78:79]
  v_cndmask_b32_e64 v29, 0, v25, s[80:81]
  s_nop 1
  v_mfma_f32_16x16x32_bf16 v[8:11], v[26:29], a[80:83], v[8:11]
  v_and_b32_dpp v25, v24, v3 row_newbcast:4 row_mask:0xf bank_mask:0xf
  v_cndmask_b32_e64 v26, 0, v25, s[74:75]
  v_cndmask_b32_e64 v27, 0, v25, s[76:77]
  v_cndmask_b32_e64 v28, 0, v25, s[78:79]
  v_cndmask_b32_e64 v29, 0, v25, s[80:81]
  s_nop 1
  v_mfma_f32_16x16x32_bf16 v[8:11], v[26:29], a[84:87], v[8:11]
  v_and_b32_dpp v25, v24, v3 row_newbcast:8 row_mask:0xf bank_mask:0xf
  v_cndmask_b32_e64 v26, 0, v25, s[74:75]
  v_cndmask_b32_e64 v27, 0, v25, s[76:77]
  v_cndmask_b32_e64 v28, 0, v25, s[78:79]
  v_cndmask_b32_e64 v29, 0, v25, s[80:81]
  s_nop 1
  v_mfma_f32_16x16x32_bf16 v[8:11], v[26:29], a[88:91], v[8:11]
  v_and_b32_dpp v25, v24, v3 row_newbcast:12 row_mask:0xf bank_mask:0xf
  v_cndmask_b32_e64 v26, 0, v25, s[74:75]
  v_cndmask_b32_e64 v27, 0, v25, s[76:77]
  v_cndmask_b32_e64 v28, 0, v25, s[78:79]
  v_cndmask_b32_e64 v29, 0, v25, s[80:81]
  s_nop 1
  v_mfma_f32_16x16x32_bf16 v[8:11], v[26:29], a[92:95], v[8:11]
  s_setpc_b64 s[60:61]
L_proc_S8_Y:
  v_cndmask_b32_e64 v26, 0, v14, s[52:53]
  v_cndmask_b32_e64 v27, 0, v15, s[52:53]
  v_cndmask_b32_e64 v28, 0, v16, s[52:53]
  v_cndmask_b32_e64 v29, 0, v17, s[52:53]
  v_mov_b32 v31, s73
  s_nop 0
  v_mfma_f32_16x16x32_bf16 v[22:25], a[64:67], v[26:29], 0
  v_cndmask_b32_e64 v26, 0, v14, s[54:55]
  v_cndmask_b32_e64 v27, 0, v15, s[54:55]
  v_cndmask_b32_e64 v28, 0, v16, s[54:55]
  v_cndmask_b32_e64 v29, 0, v17, s[54:55]
  s_nop 1
  v_mfma_f32_16x16x32_bf16 v[22:25], a[68:71], v[26:29], v[22:25]
  v_cndmask_b32_e64 v26, 0, v14, s[56:57]
  v_cndmask_b32_e64 v27, 0, v15, s[56:57]
  v_cndmask_b32_e64 v28, 0, v16, s[56:57]
  v_cndmask_b32_e64 v29, 0, v17, s[56:57]
  s_nop 1
  v_mfma_f32_16x16x32_bf16 v[22:25], a[72:75], v[26:29], v[22:25]
  v_cndmask_b32_e64 v26, 0, v14, s[58:59]
  v_cndmask_b32_e64 v27, 0, v15, s[58:59]
  v_cndmask_b32_e64 v28, 0, v16, s[58:59]
  v_cndmask_b32_e64 v29, 0, v17, s[58:59]
  s_nop 1
  v_mfma_f32_16x16x32_bf16 v[22:25], a[76:79], v[26:29], v[22:25]
  s_nop 7
  v_mov_b32_dpp v30, v22 quad_perm:[0,0,0,0] row_mask:0xf bank_mask:0xf
  v_add_f32_dpp v30, v23, v30 quad_perm:[1,1,1,1] row_mask:0xf bank_mask:0xf
  v_add_f32_dpp v30, v24, v30 quad_perm:[2,2,2,2] row_mask:0xf bank_mask:0xf
  v_add_f32_dpp v30, v25, v30 quad_perm:[3,3,3,3] row_mask:0xf bank_mask:0xf
  v_mul_f32 v30, s64, v30
  v_max_f32 v23, v30, v31
  s_nop 1
  v_max_f32_dpp v23, v23, v23 row_ror:4 row_mask:0xf bank_mask:0xf
  s_nop 1
  v_max_f32_dpp v23, v23, v23 row_ror:8 row_mask:0xf bank_mask:0xf
  s_nop 1
  v_max_f32_dpp v23, v23, v23 row_bcast:15 row_mask:0xa bank_mask:0xf
  s_nop 1
  v_max_f32_dpp v23, v23, v23 row_bcast:31 row_mask:0xc bank_mask:0xf
  s_nop 0
  v_readlane_b32 s65, v23, 63
  s_nop 1
  v_subrev_f32 v22, s65, v30
  v_subrev_f32 v23, s65, v31
  v_exp_f32 v22, v22
  v_exp_f32 v23, v23
  s_mov_b32 s73, s65
  s_nop 0
  v_cvt_pk_bf16_f32 v24, v22, v22
  v_mul_f32 v18, v23, v18
  v_mul_f32 v19, v23, v19
  v_mul_f32 v20, v23, v20
  v_mul_f32 v21, v23, v21
  v_fma_f32 v13, v13, v23, v22
  v_and_b32_dpp v25, v24, v3 row_newbcast:0 row_mask:0xf bank_mask:0xf
  v_cndmask_b32_e64 v26, 0, v25, s[74:75]
  v_cndmask_b32_e64 v27, 0, v25, s[76:77]
  v_cndmask_b32_e64 v28, 0, v25, s[78:79]
  v_cndmask_b32_e64 v29, 0, v25, s[80:81]
  s_nop 1
  v_mfma_f32_16x16x32_bf16 v[18:21], v[26:29], a[80:83], v[18:21]
  v_and_b32_dpp v25, v24, v3 row_newbcast:4 row_mask:0xf bank_mask:0xf
  v_cndmask_b32_e64 v26, 0, v25, s[74:75]
  v_cndmask_b32_e64 v27, 0, v25, s[76:77]
  v_cndmask_b32_e64 v28, 0, v25, s[78:79]
  v_cndmask_b32_e64 v29, 0, v25, s[80:81]
  s_nop 1
  v_mfma_f32_16x16x32_bf16 v[18:21], v[26:29], a[84:87], v[18:21]
  v_and_b32_dpp v25, v24, v3 row_newbcast:8 row_mask:0xf bank_mask:0xf
  v_cndmask_b32_e64 v26, 0, v25, s[74:75]
  v_cndmask_b32_e64 v27, 0, v25, s[76:77]
  v_cndmask_b32_e64 v28, 0, v25, s[78:79]
  v_cndmask_b32_e64 v29, 0, v25, s[80:81]
  s_nop 1
  v_mfma_f32_16x16x32_bf16 v[18:21], v[26:29], a[88:91], v[18:21]
  v_and_b32_dpp v25, v24, v3 row_newbcast:12 row_mask:0xf bank_mask:0xf
  v_cndmask_b32_e64 v26, 0, v25, s[74:75]
  v_cndmask_b32_e64 v27, 0, v25, s[76:77]
  v_cndmask_b32_e64 v28, 0, v25, s[78:79]
  v_cndmask_b32_e64 v29, 0, v25, s[80:81]
  s_nop 1
  v_mfma_f32_16x16x32_bf16 v[18:21], v[26:29], a[92:95], v[18:21]
  s_setpc_b64 s[60:61]
L_proc_S9_X:
  v_cndmask_b32_e64 v26, 0, v4, s[52:53]
  v_cndmask_b32_e64 v27, 0, v5, s[52:53]
  v_cndmask_b32_e64 v28, 0, v6, s[52:53]
  v_cndmask_b32_e64 v29, 0, v7, s[52:53]
  v_mov_b32 v31, s72
  s_nop 0
  v_mfma_f32_16x16x32_bf16 v[22:25], a[96:99], v[26:29], 0
  v_cndmask_b32_e64 v26, 0, v4, s[54:55]
  v_cndmask_b32_e64 v27, 0, v5, s[54:55]
  v_cndmask_b32_e64 v28, 0, v6, s[54:55]
  v_cndmask_b32_e64 v29, 0, v7, s[54:55]
  s_nop 1
  v_mfma_f32_16x16x32_bf16 v[22:25], a[100:103], v[26:29], v[22:25]
  v_cndmask_b32_e64 v26, 0, v4, s[56:57]
  v_cndmask_b32_e64 v27, 0, v5, s[56:57]
  v_cndmask_b32_e64 v28, 0, v6, s[56:57]
  v_cndmask_b32_e64 v29, 0, v7, s[56:57]
  s_nop 1
  v_mfma_f32_16x16x32_bf16 v[22:25], a[104:107], v[26:29], v[22:25]
  v_cndmask_b32_e64 v26, 0, v4, s[58:59]
  v_cndmask_b32_e64 v27, 0, v5, s[58:59]
  v_cndmask_b32_e64 v28, 0, v6, s[58:59]
  v_cndmask_b32_e64 v29, 0, v7, s[58:59]
  s_nop 1
  v_mfma_f32_16x16x32_bf16 v[22:25], a[108:111], v[26:29], v[22:25]
  s_nop 7
  v_mov_b32_dpp v30, v22 quad_perm:[0,0,0,0] row_mask:0xf bank_mask:0xf
  v_add_f32_dpp v30, v23, v30 quad_perm:[1,1,1,1] row_mask:0xf bank_mask:0xf
  v_add_f32_dpp v30, v24, v30 quad_perm:[2,2,2,2] row_mask:0xf bank_mask:0xf
  v_add_f32_dpp v30, v25, v30 quad_perm:[3,3,3,3] row_mask:0xf bank_mask:0xf
  v_mul_f32 v30, s64, v30
  v_max_f32 v23, v30, v31
  s_nop 1
  v_max_f32_dpp v23, v23, v23 row_ror:4 row_mask:0xf bank_mask:0xf
  s_nop 1
  v_max_f32_dpp v23, v23, v23 row_ror:8 row_mask:0xf bank_mask:0xf
  s_nop 1
  v_max_f32_dpp v23, v23, v23 row_bcast:15 row_mask:0xa bank_mask:0xf
  s_nop 1
  v_max_f32_dpp v23, v23, v23 row_bcast:31 row_mask:0xc bank_mask:0xf
  s_nop 0
  v_readlane_b32 s65, v23, 63
  s_nop 1
  v_subrev_f32 v22, s65, v30
  v_subrev_f32 v23, s65, v31
  v_exp_f32 v22, v22
  v_exp_f32 v23, v23
  s_mov_b32 s72, s65
  s_nop 0
  v_cvt_pk_bf16_f32 v24, v22, v22
  v_mul_f32 v8, v23, v8
  v_mul_f32 v9, v23, v9
  v_mul_f32 v10, v23, v10
  v_mul_f32 v11, v23, v11
  v_fma_f32 v12, v12, v23, v22
  v_and_b32_dpp v25, v24, v3 row_newbcast:0 row_mask:0xf bank_mask:0xf
  v_cndmask_b32_e64 v26, 0, v25, s[74:75]
  v_cndmask_b32_e64 v27, 0, v25, s[76:77]
  v_cndmask_b32_e64 v28, 0, v25, s[78:79]
  v_cndmask_b32_e64 v29, 0, v25, s[80:81]
  s_nop 1
  v_mfma_f32_16x16x32_bf16 v[8:11], v[26:29], a[112:115], v[8:11]
  v_and_b32_dpp v25, v24, v3 row_newbcast:4 row_mask:0xf bank_mask:0xf
  v_cndmask_b32_e64 v26, 0, v25, s[74:75]
  v_cndmask_b32_e64 v27, 0, v25, s[76:77]
  v_cndmask_b32_e64 v28, 0, v25, s[78:79]
  v_cndmask_b32_e64 v29, 0, v25, s[80:81]
  s_nop 1
  v_mfma_f32_16x16x32_bf16 v[8:11], v[26:29], a[116:119], v[8:11]
  v_and_b32_dpp v25, v24, v3 row_newbcast:8 row_mask:0xf bank_mask:0xf
  v_cndmask_b32_e64 v26, 0, v25, s[74:75]
  v_cndmask_b32_e64 v27, 0, v25, s[76:77]
  v_cndmask_b32_e64 v28, 0, v25, s[78:79]
  v_cndmask_b32_e64 v29, 0, v25, s[80:81]
  s_nop 1
  v_mfma_f32_16x16x32_bf16 v[8:11], v[26:29], a[120:123], v[8:11]
  v_and_b32_dpp v25, v24, v3 row_newbcast:12 row_mask:0xf bank_mask:0xf
  v_cndmask_b32_e64 v26, 0, v25, s[74:75]
  v_cndmask_b32_e64 v27, 0, v25, s[76:77]
  v_cndmask_b32_e64 v28, 0, v25, s[78:79]
  v_cndmask_b32_e64 v29, 0, v25, s[80:81]
  s_nop 1
  v_mfma_f32_16x16x32_bf16 v[8:11], v[26:29], a[124:127], v[8:11]
  s_setpc_b64 s[60:61]
L_proc_S9_Y:
  v_cndmask_b32_e64 v26, 0, v14, s[52:53]
  v_cndmask_b32_e64 v27, 0, v15, s[52:53]
  v_cndmask_b32_e64 v28, 0, v16, s[52:53]
  v_cndmask_b32_e64 v29, 0, v17, s[52:53]
  v_mov_b32 v31, s73
  s_nop 0
  v_mfma_f32_16x16x32_bf16 v[22:25], a[96:99], v[26:29], 0
  v_cndmask_b32_e64 v26, 0, v14, s[54:55]
  v_cndmask_b32_e64 v27, 0, v15, s[54:55]
  v_cndmask_b32_e64 v28, 0, v16, s[54:55]
  v_cndmask_b32_e64 v29, 0, v17, s[54:55]
  s_nop 1
  v_mfma_f32_16x16x32_bf16 v[22:25], a[100:103], v[26:29], v[22:25]
  v_cndmask_b32_e64 v26, 0, v14, s[56:57]
  v_cndmask_b32_e64 v27, 0, v15, s[56:57]
  v_cndmask_b32_e64 v28, 0, v16, s[56:57]
  v_cndmask_b32_e64 v29, 0, v17, s[56:57]
  s_nop 1
  v_mfma_f32_16x16x32_bf16 v[22:25], a[104:107], v[26:29], v[22:25]
  v_cndmask_b32_e64 v26, 0, v14, s[58:59]
  v_cndmask_b32_e64 v27, 0, v15, s[58:59]
  v_cndmask_b32_e64 v28, 0, v16, s[58:59]
  v_cndmask_b32_e64 v29, 0, v17, s[58:59]
  s_nop 1
  v_mfma_f32_16x16x32_bf16 v[22:25], a[108:111], v[26:29], v[22:25]
  s_nop 7
  v_mov_b32_dpp v30, v22 quad_perm:[0,0,0,0] row_mask:0xf bank_mask:0xf
  v_add_f32_dpp v30, v23, v30 quad_perm:[1,1,1,1] row_mask:0xf bank_mask:0xf
  v_add_f32_dpp v30, v24, v30 quad_perm:[2,2,2,2] row_mask:0xf bank_mask:0xf
  v_add_f32_dpp v30, v25, v30 quad_perm:[3,3,3,3] row_mask:0xf bank_mask:0xf
  v_mul_f32 v30, s64, v30
  v_max_f32 v23, v30, v31
  s_nop 1
  v_max_f32_dpp v23, v23, v23 row_ror:4 row_mask:0xf bank_mask:0xf
  s_nop 1
  v_max_f32_dpp v23, v23, v23 row_ror:8 row_mask:0xf bank_mask:0xf
  s_nop 1
  v_max_f32_dpp v23, v23, v23 row_bcast:15 row_mask:0xa bank_mask:0xf
  s_nop 1
  v_max_f32_dpp v23, v23, v23 row_bcast:31 row_mask:0xc bank_mask:0xf
  s_nop 0
  v_readlane_b32 s65, v23, 63
  s_nop 1
  v_subrev_f32 v22, s65, v30
  v_subrev_f32 v23, s65, v31
  v_exp_f32 v22, v22
  v_exp_f32 v23, v23
  s_mov_b32 s73, s65
  s_nop 0
  v_cvt_pk_bf16_f32 v24, v22, v22
  v_mul_f32 v18, v23, v18
  v_mul_f32 v19, v23, v19
  v_mul_f32 v20, v23, v20
  v_mul_f32 v21, v23, v21
  v_fma_f32 v13, v13, v23, v22
  v_and_b32_dpp v25, v24, v3 row_newbcast:0 row_mask:0xf bank_mask:0xf
  v_cndmask_b32_e64 v26, 0, v25, s[74:75]
  v_cndmask_b32_e64 v27, 0, v25, s[76:77]
  v_cndmask_b32_e64 v28, 0, v25, s[78:79]
  v_cndmask_b32_e64 v29, 0, v25, s[80:81]
  s_nop 1
  v_mfma_f32_16x16x32_bf16 v[18:21], v[26:29], a[112:115], v[18:21]
  v_and_b32_dpp v25, v24, v3 row_newbcast:4 row_mask:0xf bank_mask:0xf
  v_cndmask_b32_e64 v26, 0, v25, s[74:75]
  v_cndmask_b32_e64 v27, 0, v25, s[76:77]
  v_cndmask_b32_e64 v28, 0, v25, s[78:79]
  v_cndmask_b32_e64 v29, 0, v25, s[80:81]
  s_nop 1
  v_mfma_f32_16x16x32_bf16 v[18:21], v[26:29], a[116:119], v[18:21]
  v_and_b32_dpp v25, v24, v3 row_newbcast:8 row_mask:0xf bank_mask:0xf
  v_cndmask_b32_e64 v26, 0, v25, s[74:75]
  v_cndmask_b32_e64 v27, 0, v25, s[76:77]
  v_cndmask_b32_e64 v28, 0, v25, s[78:79]
  v_cndmask_b32_e64 v29, 0, v25, s[80:81]
  s_nop 1
  v_mfma_f32_16x16x32_bf16 v[18:21], v[26:29], a[120:123], v[18:21]
  v_and_b32_dpp v25, v24, v3 row_newbcast:12 row_mask:0xf bank_mask:0xf
  v_cndmask_b32_e64 v26, 0, v25, s[74:75]
  v_cndmask_b32_e64 v27, 0, v25, s[76:77]
  v_cndmask_b32_e64 v28, 0, v25, s[78:79]
  v_cndmask_b32_e64 v29, 0, v25, s[80:81]
  s_nop 1
  v_mfma_f32_16x16x32_bf16 v[18:21], v[26:29], a[124:127], v[18:21]
  s_setpc_b64 s[60:61]
L_chain:
  v_and_b32 v2, 15, v0
  v_lshrrev_b32 v3, 1, v2
  v_and_b32 v1, 1, v0
  v_mov_b32 v8, 0xffff
  v_lshlrev_b32 v1, 4, v1
  v_lshlrev_b32 v8, v1, v8
  v_cmp_eq_u32 vcc, 0, v3
  s_nop 1
  v_cndmask_b32 v4, 0, v8, vcc
  v_cmp_eq_u32 vcc, 1, v3
  s_nop 1
  v_cndmask_b32 v5, 0, v8, vcc
  v_cmp_eq_u32 vcc, 2, v3
  s_nop 1
  v_cndmask_b32 v6, 0, v8, vcc
  v_cmp_eq_u32 vcc, 3, v3
  s_nop 1
  v_cndmask_b32 v7, 0, v8, vcc
  s_waitcnt lgkmcnt(0)
  s_mov_b32 s36, s26
  s_and_b32 s37, s27, 0xffff
  s_mov_b32 s38, 0x400000
  s_mov_b32 s39, 0x20000
  s_mov_b32 s40, s24
  s_and_b32 s41, s25, 0xffff
  s_mov_b32 s42, 0x100
  s_mov_b32 s43, 0x20000
  s_mov_b32 s28, s4
  s_and_b32 s29, s5, 0xffff
  s_mov_b32 s30, 0x800
  s_mov_b32 s31, 0x20000
  s_mov_b32 s32, s10
  s_and_b32 s33, s11, 0xffff
  s_mov_b32 s34, 0x400000
  s_mov_b32 s35, 0x20000
  s_mov_b32 s44, s12
  s_and_b32 s45, s13, 0xffff
  s_mov_b32 s46, 0x400000
  s_mov_b32 s47, 0x20000
  s_mov_b32 s48, s16
  s_and_b32 s49, s17, 0xffff
  s_mov_b32 s50, 0x158000
  s_mov_b32 s51, 0x20000
  s_mov_b32 s52, s18
  s_and_b32 s53, s19, 0xffff
  s_mov_b32 s54, 0x158000
  s_mov_b32 s55, 0x20000
  s_mov_b32 s56, s20
  s_and_b32 s57, s21, 0xffff
  s_mov_b32 s58, 0x158000
  s_mov_b32 s59, 0x20000
  s_mov_b32 s60, s22
  s_and_b32 s61, s23, 0xffff
  s_mov_b32 s62, 0x800
  s_mov_b32 s63, 0x20000
  v_lshrrev_b32 v34, 4, v0
  v_and_b32 v35, 15, v0
  v_lshlrev_b32 v36, 4, v35
  v_lshlrev_b32 v37, 13, v34
  v_add_u32 v2, v37, v36
  s_lshl_b32 s70, s2, 2
  s_add_u32 s70, s70, s3
  s_mul_i32 s70, s70, 4096
  s_add_u32 s70, s70, 8192
  v_mov_b32 v48, -1
  v_mov_b32 v49, -1
  v_mov_b32 v50, -1
  v_mov_b32 v51, -1
  v_lshlrev_b32 v40, 4, v0
  buffer_store_dwordx4 v[48:51], v40, s[36:39], s70 offen offset:0 sc0 sc1
  buffer_store_dwordx4 v[48:51], v40, s[36:39], s70 offen offset:1024 sc0 sc1
  buffer_store_dwordx4 v[48:51], v40, s[36:39], s70 offen offset:2048 sc0 sc1
  buffer_store_dwordx4 v[48:51], v40, s[36:39], s70 offen offset:3072 sc0 sc1
  v_mov_b32 v44, 56
  v_mov_b32 v45, 0
  s_lshl_b32 s70, s2, 8
  s_mov_b64 exec, 1
  buffer_store_dword v44, v45, s[36:39], s70 offen sc0 sc1
  s_mov_b64 exec, -1
  v_and_b32 v38, 31, v0
  v_lshlrev_b32 v124, 4, v38
  s_lshl_b32 s70, s3, 9
  v_add_u32 v118, s70, v124
  v_lshrrev_b32 v38, 5, v0
  v_lshl_add_u32 v117, v38, 11, v118
  v_lshlrev_b32 v39, 10, v38
  v_lshrrev_b32 v40, 1, v118
  v_add_u32 v39, v39, v40
  buffer_load_dwordx2 v[42:43], v39, s[28:31], 0 offen
  s_lshl_b32 s70, s3, 20
  s_lshl_b32 s71, s2, 8
  s_add_u32 s72, s70, s71
  s_waitcnt vmcnt(0)
  s_barrier
  s_cmp_lg_u32 s3, 0
  s_cbranch_scc1 L_nosig_40
  v_mov_b32 v44, 1
  v_mov_b32 v45, 0
  s_mov_b64 exec, 1
  buffer_atomic_add v44, v45, s[40:43], 0 offen sc1
  s_mov_b64 exec, -1
L_nosig_40:
  buffer_load_dwordx4 a[128:131], v2, s[32:35], s72 offen nt
  s_add_u32 s72, s72, 32768
  buffer_load_dwordx4 a[132:135], v2, s[32:35], s72 offen nt
  s_add_u32 s72, s72, 32768
  buffer_load_dwordx4 a[136:139], v2, s[32:35], s72 offen nt
  s_add_u32 s72, s72, 32768
  buffer_load_dwordx4 a[140:143], v2, s[32:35], s72 offen nt
  s_add_u32 s72, s72, 32768
  buffer_load_dwordx4 a[144:147], v2, s[32:35], s72 offen nt
  s_add_u32 s72, s72, 32768
  buffer_load_dwordx4 a[148:151], v2, s[32:35], s72 offen nt
  s_add_u32 s72, s72, 32768
  buffer_load_dwordx4 a[152:155], v2, s[32:35], s72 offen nt
  s_add_u32 s72, s72, 32768
  buffer_load_dwordx4 a[156:159], v2, s[32:35], s72 offen nt
  s_add_u32 s72, s72, 32768
  buffer_load_dwordx4 a[160:163], v2, s[32:35], s72 offen nt
  s_add_u32 s72, s72, 32768
  buffer_load_dwordx4 a[164:167], v2, s[32:35], s72 offen nt
  s_add_u32 s72, s72, 32768
  buffer_load_dwordx4 a[168:171], v2, s[32:35], s72 offen nt
  s_add_u32 s72, s72, 32768
  buffer_load_dwordx4 a[172:175], v2, s[32:35], s72 offen nt
  s_add_u32 s72, s72, 32768
  buffer_load_dwordx4 a[176:179], v2, s[32:35], s72 offen nt
  s_add_u32 s72, s72, 32768
  buffer_load_dwordx4 a[180:183], v2, s[32:35], s72 offen nt
  s_add_u32 s72, s72, 32768
  buffer_load_dwordx4 a[184:187], v2, s[32:35], s72 offen nt
  s_add_u32 s72, s72, 32768
  buffer_load_dwordx4 a[188:191], v2, s[32:35], s72 offen nt
  s_add_u32 s72, s72, 32768
  buffer_load_dwordx4 a[192:195], v2, s[32:35], s72 offen nt
  s_add_u32 s72, s72, 32768
  buffer_load_dwordx4 a[196:199], v2, s[32:35], s72 offen nt
  s_add_u32 s72, s72, 32768
  buffer_load_dwordx4 a[200:203], v2, s[32:35], s72 offen nt
  s_add_u32 s72, s72, 32768
  buffer_load_dwordx4 a[204:207], v2, s[32:35], s72 offen nt
  s_add_u32 s72, s72, 32768
  buffer_load_dwordx4 a[208:211], v2, s[32:35], s72 offen nt
  s_add_u32 s72, s72, 32768
  buffer_load_dwordx4 a[212:215], v2, s[32:35], s72 offen nt
  s_add_u32 s72, s72, 32768
  buffer_load_dwordx4 a[216:219], v2, s[32:35], s72 offen nt
  s_add_u32 s72, s72, 32768
  buffer_load_dwordx4 a[220:223], v2, s[32:35], s72 offen nt
  s_add_u32 s72, s72, 32768
  buffer_load_dwordx4 a[224:227], v2, s[32:35], s72 offen nt
  s_add_u32 s72, s72, 32768
  buffer_load_dwordx4 a[228:231], v2, s[32:35], s72 offen nt
  s_add_u32 s72, s72, 32768
  buffer_load_dwordx4 a[232:235], v2, s[32:35], s72 offen nt
  s_add_u32 s72, s72, 32768
  buffer_load_dwordx4 a[236:239], v2, s[32:35], s72 offen nt
  s_add_u32 s72, s72, 32768
  buffer_load_dwordx4 a[240:243], v2, s[32:35], s72 offen nt
  s_add_u32 s72, s72, 32768
  buffer_load_dwordx4 a[244:247], v2, s[32:35], s72 offen nt
  s_add_u32 s72, s72, 32768
  buffer_load_dwordx4 a[248:251], v2, s[32:35], s72 offen nt
  s_add_u32 s72, s72, 32768
  buffer_load_dwordx4 a[252:255], v2, s[32:35], s72 offen nt
  s_add_u32 s72, s72, 32768
  v_lshlrev_b32 v37, 10, v34
  v_add_u32 v1, v37, v36
  v_mul_u32_u24 v37, 2752, v34
  v_and_b32 v38, 7, v0
  v_lshlrev_b32 v38, 4, v38
  v_add_u32 v3, v37, v38
  v_lshl_add_u32 v37, v35, 2, v34
  v_lshlrev_b32 v119, 2, v37
  s_lshl_b32 s70, s2, 6
  s_lshl_b32 s71, s3, 4
  s_add_u32 s70, s70, s71
  v_add_u32 v123, s70, v37
  v_lshrrev_b32 v39, 3, v0
  v_mul_u32_u24 v112, 640, v39
  s_lshl_b32 s70, s3, 7
  v_add3_u32 v113, v112, v38, s70
  v_add_u32 v112, 512, v112
  v_min_u32 v39, 3, v39
  v_mul_u32_u24 v115, 640, v39
  v_add3_u32 v114, v115, v38, s70
  v_add_u32 v115, 512, v115
  s_mov_b32 s76, 0xffffffff
  s_mov_b32 s77, 0x0
  v_lshlrev_b32 v116, 5, v35
  v_lshl_add_u32 v116, v34, 4, v116
  v_lshlrev_b32 v120, 5, v0
  s_lshl_b32 s70, s3, 9
  s_add_u32 s70, s70, 12288
  v_lshl_add_u32 v121, v34, 7, v38
  v_add_u32 v121, s70, v121
  v_add_u32 v122, s70, v119
  s_branch L_chain_main
L_qproj:
  v_add_u32 v34, s69, v120
  ds_read_b128 v[48:51], v34
  ds_read_b128 v[52:55], v34 offset:16
  s_lshl_b32 s70, s3, 9
  s_add_u32 s70, s70, s69
  v_add_u32 v35, s70, v119
  ds_read_b32 v8, v35
  ds_read_b32 v9, v35 offset:256
  s_waitcnt lgkmcnt(0)
  v_add_f32 v36, v48, v49
  v_add_f32 v36, v36, v50
  v_add_f32 v36, v36, v51
  v_add_f32 v36, v36, v52
  v_add_f32 v36, v36, v53
  v_add_f32 v36, v36, v54
  v_add_f32 v36, v36, v55
  s_nop 1
  v_add_f32_dpp v36, v36, v36 row_ror:1 row_mask:0xf bank_mask:0xf
  s_nop 1
  v_add_f32_dpp v36, v36, v36 row_ror:2 row_mask:0xf bank_mask:0xf
  s_nop 1
  v_add_f32_dpp v36, v36, v36 row_ror:4 row_mask:0xf bank_mask:0xf
  s_nop 1
  v_add_f32_dpp v36, v36, v36 row_ror:8 row_mask:0xf bank_mask:0xf
  s_nop 1
  v_add_f32_dpp v36, v36, v36 row_bcast:15 row_mask:0xa bank_mask:0xf
  s_nop 1
  v_add_f32_dpp v36, v36, v36 row_bcast:31 row_mask:0xc bank_mask:0xf
  s_nop 0
  v_readlane_b32 s73, v36, 63
  s_nop 1
  v_mov_b32 v37, s73
  v_mul_f32 v37, 0x3b000000, v37
  v_sub_f32 v38, v48, v37
  v_mul_f32 v36, v38, v38
  v_sub_f32 v38, v49, v37
  v_fmac_f32 v36, v38, v38
  v_sub_f32 v38, v50, v37
  v_fmac_f32 v36, v38, v38
  v_sub_f32 v38, v51, v37
  v_fmac_f32 v36, v38, v38
  v_sub_f32 v38, v52, v37
  v_fmac_f32 v36, v38, v38
  v_sub_f32 v38, v53, v37
  v_fmac_f32 v36, v38, v38
  v_sub_f32 v38, v54, v37
  v_fmac_f32 v36, v38, v38
  v_sub_f32 v38, v55, v37
  v_fmac_f32 v36, v38, v38
  s_nop 1
  v_add_f32_dpp v36, v36, v36 row_ror:1 row_mask:0xf bank_mask:0xf
  s_nop 1
  v_add_f32_dpp v36, v36, v36 row_ror:2 row_mask:0xf bank_mask:0xf
  s_nop 1
  v_add_f32_dpp v36, v36, v36 row_ror:4 row_mask:0xf bank_mask:0xf
  s_nop 1
  v_add_f32_dpp v36, v36, v36 row_ror:8 row_mask:0xf bank_mask:0xf
  s_nop 1
  v_add_f32_dpp v36, v36, v36 row_bcast:15 row_mask:0xa bank_mask:0xf
  s_nop 1
  v_add_f32_dpp v36, v36, v36 row_bcast:31 row_mask:0xc bank_mask:0xf
  s_nop 0
  v_readlane_b32 s74, v36, 63
  s_nop 1
  v_mov_b32 v38, s74
  v_mul_f32 v38, 0x3b000000, v38
  v_cvt_pk_bf16_f32 v38, v38, v38
  v_and_b32 v38, 0xffff0000, v38
  v_add_f32 v38, 0x3727c5ac, v38
  v_cvt_pk_bf16_f32 v38, v38, v38
  v_and_b32 v38, 0xffff0000, v38
  v_sqrt_f32 v38, v38
  s_nop 0
  v_cvt_pk_bf16_f32 v38, v38, v38
  v_and_b32 v38, 0xffff0000, v38
  v_rcp_f32 v38, v38
  v_cvt_pk_bf16_f32 v37, v37, v37
  v_and_b32 v37, 0xffff0000, v37
  v_sub_f32 v8, v8, v37
  v_cvt_pk_bf16_f32 v8, v8, v8
  v_and_b32 v8, 0xffff0000, v8
  v_mul_f32 v8, v8, v38
  v_cvt_pk_bf16_f32 v8, v8, v8
  v_sub_f32 v9, v9, v37
  v_cvt_pk_bf16_f32 v9, v9, v9
  v_and_b32 v9, 0xffff0000, v9
  v_mul_f32 v9, v9, v38
  v_cvt_pk_bf16_f32 v9, v9, v9
  s_nop 1
  v_and_b32_dpp v10, v8, v4 row_newbcast:0 row_mask:0xf bank_mask:0xf
  v_and_b32_dpp v11, v8, v5 row_newbcast:0 row_mask:0xf bank_mask:0xf
  v_and_b32_dpp v12, v8, v6 row_newbcast:0 row_mask:0xf bank_mask:0xf
  v_and_b32_dpp v13, v8, v7 row_newbcast:0 row_mask:0xf bank_mask:0xf
  v_and_b32_dpp v14, v8, v4 row_newbcast:1 row_mask:0xf bank_mask:0xf
  v_and_b32_dpp v15, v8, v5 row_newbcast:1 row_mask:0xf bank_mask:0xf
  v_and_b32_dpp v16, v8, v6 row_newbcast:1 row_mask:0xf bank_mask:0xf
  v_and_b32_dpp v17, v8, v7 row_newbcast:1 row_mask:0xf bank_mask:0xf
  v_mfma_f32_16x16x32_bf16 v[18:21], v[10:13], a[128:131], 0
  v_and_b32_dpp v10, v8, v4 row_newbcast:2 row_mask:0xf bank_mask:0xf
  v_and_b32_dpp v11, v8, v5 row_newbcast:2 row_mask:0xf bank_mask:0xf
  v_and_b32_dpp v12, v8, v6 row_newbcast:2 row_mask:0xf bank_mask:0xf
  v_and_b32_dpp v13, v8, v7 row_newbcast:2 row_mask:0xf bank_mask:0xf
  v_mfma_f32_16x16x32_bf16 v[18:21], v[14:17], a[132:135], v[18:21]
  v_and_b32_dpp v14, v8, v4 row_newbcast:3 row_mask:0xf bank_mask:0xf
  v_and_b32_dpp v15, v8, v5 row_newbcast:3 row_mask:0xf bank_mask:0xf
  v_and_b32_dpp v16, v8, v6 row_newbcast:3 row_mask:0xf bank_mask:0xf
  v_and_b32_dpp v17, v8, v7 row_newbcast:3 row_mask:0xf bank_mask:0xf
  v_mfma_f32_16x16x32_bf16 v[18:21], v[10:13], a[136:139], v[18:21]
  v_and_b32_dpp v10, v8, v4 row_newbcast:4 row_mask:0xf bank_mask:0xf
  v_and_b32_dpp v11, v8, v5 row_newbcast:4 row_mask:0xf bank_mask:0xf
  v_and_b32_dpp v12, v8, v6 row_newbcast:4 row_mask:0xf bank_mask:0xf
  v_and_b32_dpp v13, v8, v7 row_newbcast:4 row_mask:0xf bank_mask:0xf
  v_mfma_f32_16x16x32_bf16 v[18:21], v[14:17], a[140:143], v[18:21]
  v_and_b32_dpp v14, v8, v4 row_newbcast:5 row_mask:0xf bank_mask:0xf
  v_and_b32_dpp v15, v8, v5 row_newbcast:5 row_mask:0xf bank_mask:0xf
  v_and_b32_dpp v16, v8, v6 row_newbcast:5 row_mask:0xf bank_mask:0xf
  v_and_b32_dpp v17, v8, v7 row_newbcast:5 row_mask:0xf bank_mask:0xf
  v_mfma_f32_16x16x32_bf16 v[18:21], v[10:13], a[144:147], v[18:21]
  v_and_b32_dpp v10, v8, v4 row_newbcast:6 row_mask:0xf bank_mask:0xf
  v_and_b32_dpp v11, v8, v5 row_newbcast:6 row_mask:0xf bank_mask:0xf
  v_and_b32_dpp v12, v8, v6 row_newbcast:6 row_mask:0xf bank_mask:0xf
  v_and_b32_dpp v13, v8, v7 row_newbcast:6 row_mask:0xf bank_mask:0xf
  v_mfma_f32_16x16x32_bf16 v[18:21], v[14:17], a[148:151], v[18:21]
  v_and_b32_dpp v14, v8, v4 row_newbcast:7 row_mask:0xf bank_mask:0xf
  v_and_b32_dpp v15, v8, v5 row_newbcast:7 row_mask:0xf bank_mask:0xf
  v_and_b32_dpp v16, v8, v6 row_newbcast:7 row_mask:0xf bank_mask:0xf
  v_and_b32_dpp v17, v8, v7 row_newbcast:7 row_mask:0xf bank_mask:0xf
  v_mfma_f32_16x16x32_bf16 v[18:21], v[10:13], a[152:155], v[18:21]
  v_and_b32_dpp v10, v8, v4 row_newbcast:8 row_mask:0xf bank_mask:0xf
  v_and_b32_dpp v11, v8, v5 row_newbcast:8 row_mask:0xf bank_mask:0xf
  v_and_b32_dpp v12, v8, v6 row_newbcast:8 row_mask:0xf bank_mask:0xf
  v_and_b32_dpp v13, v8, v7 row_newbcast:8 row_mask:0xf bank_mask:0xf
  v_mfma_f32_16x16x32_bf16 v[18:21], v[14:17], a[156:159], v[18:21]
  v_and_b32_dpp v14, v8, v4 row_newbcast:9 row_mask:0xf bank_mask:0xf
  v_and_b32_dpp v15, v8, v5 row_newbcast:9 row_mask:0xf bank_mask:0xf
  v_and_b32_dpp v16, v8, v6 row_newbcast:9 row_mask:0xf bank_mask:0xf
  v_and_b32_dpp v17, v8, v7 row_newbcast:9 row_mask:0xf bank_mask:0xf
  v_mfma_f32_16x16x32_bf16 v[18:21], v[10:13], a[160:163], v[18:21]
  v_and_b32_dpp v10, v8, v4 row_newbcast:10 row_mask:0xf bank_mask:0xf
  v_and_b32_dpp v11, v8, v5 row_newbcast:10 row_mask:0xf bank_mask:0xf
  v_and_b32_dpp v12, v8, v6 row_newbcast:10 row_mask:0xf bank_mask:0xf
  v_and_b32_dpp v13, v8, v7 row_newbcast:10 row_mask:0xf bank_mask:0xf
  v_mfma_f32_16x16x32_bf16 v[18:21], v[14:17], a[164:167], v[18:21]
  v_and_b32_dpp v14, v8, v4 row_newbcast:11 row_mask:0xf bank_mask:0xf
  v_and_b32_dpp v15, v8, v5 row_newbcast:11 row_mask:0xf bank_mask:0xf
  v_and_b32_dpp v16, v8, v6 row_newbcast:11 row_mask:0xf bank_mask:0xf
  v_and_b32_dpp v17, v8, v7 row_newbcast:11 row_mask:0xf bank_mask:0xf
  v_mfma_f32_16x16x32_bf16 v[18:21], v[10:13], a[168:171], v[18:21]
  v_and_b32_dpp v10, v8, v4 row_newbcast:12 row_mask:0xf bank_mask:0xf
  v_and_b32_dpp v11, v8, v5 row_newbcast:12 row_mask:0xf bank_mask:0xf
  v_and_b32_dpp v12, v8, v6 row_newbcast:12 row_mask:0xf bank_mask:0xf
  v_and_b32_dpp v13, v8, v7 row_newbcast:12 row_mask:0xf bank_mask:0xf
  v_mfma_f32_16x16x32_bf16 v[18:21], v[14:17], a[172:175], v[18:21]
  v_and_b32_dpp v14, v8, v4 row_newbcast:13 row_mask:0xf bank_mask:0xf
  v_and_b32_dpp v15, v8, v5 row_newbcast:13 row_mask:0xf bank_mask:0xf
  v_and_b32_dpp v16, v8, v6 row_newbcast:13 row_mask:0xf bank_mask:0xf
  v_and_b32_dpp v17, v8, v7 row_newbcast:13 row_mask:0xf bank_mask:0xf
  v_mfma_f32_16x16x32_bf16 v[18:21], v[10:13], a[176:179], v[18:21]
  v_and_b32_dpp v10, v8, v4 row_newbcast:14 row_mask:0xf bank_mask:0xf
  v_and_b32_dpp v11, v8, v5 row_newbcast:14 row_mask:0xf bank_mask:0xf
  v_and_b32_dpp v12, v8, v6 row_newbcast:14 row_mask:0xf bank_mask:0xf
  v_and_b32_dpp v13, v8, v7 row_newbcast:14 row_mask:0xf bank_mask:0xf
  v_mfma_f32_16x16x32_bf16 v[18:21], v[14:17], a[180:183], v[18:21]
  v_and_b32_dpp v14, v8, v4 row_newbcast:15 row_mask:0xf bank_mask:0xf
  v_and_b32_dpp v15, v8, v5 row_newbcast:15 row_mask:0xf bank_mask:0xf
  v_and_b32_dpp v16, v8, v6 row_newbcast:15 row_mask:0xf bank_mask:0xf
  v_and_b32_dpp v17, v8, v7 row_newbcast:15 row_mask:0xf bank_mask:0xf
  v_mfma_f32_16x16x32_bf16 v[18:21], v[10:13], a[184:187], v[18:21]
  v_and_b32_dpp v10, v9, v4 row_newbcast:0 row_mask:0xf bank_mask:0xf
  v_and_b32_dpp v11, v9, v5 row_newbcast:0 row_mask:0xf bank_mask:0xf
  v_and_b32_dpp v12, v9, v6 row_newbcast:0 row_mask:0xf bank_mask:0xf
  v_and_b32_dpp v13, v9, v7 row_newbcast:0 row_mask:0xf bank_mask:0xf
  v_mfma_f32_16x16x32_bf16 v[18:21], v[14:17], a[188:191], v[18:21]
  v_and_b32_dpp v14, v9, v4 row_newbcast:1 row_mask:0xf bank_mask:0xf
  v_and_b32_dpp v15, v9, v5 row_newbcast:1 row_mask:0xf bank_mask:0xf
  v_and_b32_dpp v16, v9, v6 row_newbcast:1 row_mask:0xf bank_mask:0xf
  v_and_b32_dpp v17, v9, v7 row_newbcast:1 row_mask:0xf bank_mask:0xf
  v_mfma_f32_16x16x32_bf16 v[18:21], v[10:13], a[192:195], v[18:21]
  v_and_b32_dpp v10, v9, v4 row_newbcast:2 row_mask:0xf bank_mask:0xf
  v_and_b32_dpp v11, v9, v5 row_newbcast:2 row_mask:0xf bank_mask:0xf
  v_and_b32_dpp v12, v9, v6 row_newbcast:2 row_mask:0xf bank_mask:0xf
  v_and_b32_dpp v13, v9, v7 row_newbcast:2 row_mask:0xf bank_mask:0xf
  v_mfma_f32_16x16x32_bf16 v[18:21], v[14:17], a[196:199], v[18:21]
  v_and_b32_dpp v14, v9, v4 row_newbcast:3 row_mask:0xf bank_mask:0xf
  v_and_b32_dpp v15, v9, v5 row_newbcast:3 row_mask:0xf bank_mask:0xf
  v_and_b32_dpp v16, v9, v6 row_newbcast:3 row_mask:0xf bank_mask:0xf
  v_and_b32_dpp v17, v9, v7 row_newbcast:3 row_mask:0xf bank_mask:0xf
  v_mfma_f32_16x16x32_bf16 v[18:21], v[10:13], a[200:203], v[18:21]
  v_and_b32_dpp v10, v9, v4 row_newbcast:4 row_mask:0xf bank_mask:0xf
  v_and_b32_dpp v11, v9, v5 row_newbcast:4 row_mask:0xf bank_mask:0xf
  v_and_b32_dpp v12, v9, v6 row_newbcast:4 row_mask:0xf bank_mask:0xf
  v_and_b32_dpp v13, v9, v7 row_newbcast:4 row_mask:0xf bank_mask:0xf
  v_mfma_f32_16x16x32_bf16 v[18:21], v[14:17], a[204:207], v[18:21]
  v_and_b32_dpp v14, v9, v4 row_newbcast:5 row_mask:0xf bank_mask:0xf
  v_and_b32_dpp v15, v9, v5 row_newbcast:5 row_mask:0xf bank_mask:0xf
  v_and_b32_dpp v16, v9, v6 row_newbcast:5 row_mask:0xf bank_mask:0xf
  v_and_b32_dpp v17, v9, v7 row_newbcast:5 row_mask:0xf bank_mask:0xf
  v_mfma_f32_16x16x32_bf16 v[18:21], v[10:13], a[208:211], v[18:21]
  v_and_b32_dpp v10, v9, v4 row_newbcast:6 row_mask:0xf bank_mask:0xf
  v_and_b32_dpp v11, v9, v5 row_newbcast:6 row_mask:0xf bank_mask:0xf
  v_and_b32_dpp v12, v9, v6 row_newbcast:6 row_mask:0xf bank_mask:0xf
  v_and_b32_dpp v13, v9, v7 row_newbcast:6 row_mask:0xf bank_mask:0xf
  v_mfma_f32_16x16x32_bf16 v[18:21], v[14:17], a[212:215], v[18:21]
  v_and_b32_dpp v14, v9, v4 row_newbcast:7 row_mask:0xf bank_mask:0xf
  v_and_b32_dpp v15, v9, v5 row_newbcast:7 row_mask:0xf bank_mask:0xf
  v_and_b32_dpp v16, v9, v6 row_newbcast:7 row_mask:0xf bank_mask:0xf
  v_and_b32_dpp v17, v9, v7 row_newbcast:7 row_mask:0xf bank_mask:0xf
  v_mfma_f32_16x16x32_bf16 v[18:21], v[10:13], a[216:219], v[18:21]
  v_and_b32_dpp v10, v9, v4 row_newbcast:8 row_mask:0xf bank_mask:0xf
  v_and_b32_dpp v11, v9, v5 row_newbcast:8 row_mask:0xf bank_mask:0xf
  v_and_b32_dpp v12, v9, v6 row_newbcast:8 row_mask:0xf bank_mask:0xf
  v_and_b32_dpp v13, v9, v7 row_newbcast:8 row_mask:0xf bank_mask:0xf
  v_mfma_f32_16x16x32_bf16 v[18:21], v[14:17], a[220:223], v[18:21]
  v_and_b32_dpp v14, v9, v4 row_newbcast:9 row_mask:0xf bank_mask:0xf
  v_and_b32_dpp v15, v9, v5 row_newbcast:9 row_mask:0xf bank_mask:0xf
  v_and_b32_dpp v16, v9, v6 row_newbcast:9 row_mask:0xf bank_mask:0xf
  v_and_b32_dpp v17, v9, v7 row_newbcast:9 row_mask:0xf bank_mask:0xf
  v_mfma_f32_16x16x32_bf16 v[18:21], v[10:13], a[224:227], v[18:21]
  v_and_b32_dpp v10, v9, v4 row_newbcast:10 row_mask:0xf bank_mask:0xf
  v_and_b32_dpp v11, v9, v5 row_newbcast:10 row_mask:0xf bank_mask:0xf
  v_and_b32_dpp v12, v9, v6 row_newbcast:10 row_mask:0xf bank_mask:0xf
  v_and_b32_dpp v13, v9, v7 row_newbcast:10 row_mask:0xf bank_mask:0xf
  v_mfma_f32_16x16x32_bf16 v[18:21], v[14:17], a[228:231], v[18:21]
  v_and_b32_dpp v14, v9, v4 row_newbcast:11 row_mask:0xf bank_mask:0xf
  v_and_b32_dpp v15, v9, v5 row_newbcast:11 row_mask:0xf bank_mask:0xf
  v_and_b32_dpp v16, v9, v6 row_newbcast:11 row_mask:0xf bank_mask:0xf
  v_and_b32_dpp v17, v9, v7 row_newbcast:11 row_mask:0xf bank_mask:0xf
  v_mfma_f32_16x16x32_bf16 v[18:21], v[10:13], a[232:235], v[18:21]
  v_and_b32_dpp v10, v9, v4 row_newbcast:12 row_mask:0xf bank_mask:0xf
  v_and_b32_dpp v11, v9, v5 row_newbcast:12 row_mask:0xf bank_mask:0xf
  v_and_b32_dpp v12, v9, v6 row_newbcast:12 row_mask:0xf bank_mask:0xf
  v_and_b32_dpp v13, v9, v7 row_newbcast:12 row_mask:0xf bank_mask:0xf
  v_mfma_f32_16x16x32_bf16 v[18:21], v[14:17], a[236:239], v[18:21]
  v_and_b32_dpp v14, v9, v4 row_newbcast:13 row_mask:0xf bank_mask:0xf
  v_and_b32_dpp v15, v9, v5 row_newbcast:13 row_mask:0xf bank_mask:0xf
  v_and_b32_dpp v16, v9, v6 row_newbcast:13 row_mask:0xf bank_mask:0xf
  v_and_b32_dpp v17, v9, v7 row_newbcast:13 row_mask:0xf bank_mask:0xf
  v_mfma_f32_16x16x32_bf16 v[18:21], v[10:13], a[240:243], v[18:21]
  v_and_b32_dpp v10, v9, v4 row_newbcast:14 row_mask:0xf bank_mask:0xf
  v_and_b32_dpp v11, v9, v5 row_newbcast:14 row_mask:0xf bank_mask:0xf
  v_and_b32_dpp v12, v9, v6 row_newbcast:14 row_mask:0xf bank_mask:0xf
  v_and_b32_dpp v13, v9, v7 row_newbcast:14 row_mask:0xf bank_mask:0xf
  v_mfma_f32_16x16x32_bf16 v[18:21], v[14:17], a[244:247], v[18:21]
  v_and_b32_dpp v14, v9, v4 row_newbcast:15 row_mask:0xf bank_mask:0xf
  v_and_b32_dpp v15, v9, v5 row_newbcast:15 row_mask:0xf bank_mask:0xf
  v_and_b32_dpp v16, v9, v6 row_newbcast:15 row_mask:0xf bank_mask:0xf
  v_and_b32_dpp v17, v9, v7 row_newbcast:15 row_mask:0xf bank_mask:0xf
  v_mfma_f32_16x16x32_bf16 v[18:21], v[10:13], a[248:251], v[18:21]
  s_nop 0
  v_mfma_f32_16x16x32_bf16 v[18:21], v[14:17], a[252:255], v[18:21]
  s_nop 7
  s_lshl_b32 s70, s3, 11
  s_add_u32 s70, s70, 4096
  v_add_u32 v34, s70, v116
  s_mov_b32 exec_hi, 0
  ds_write_b128 v34, v[18:21] offset:0
  s_mov_b32 exec_hi, -1
  s_waitcnt lgkmcnt(0)
  s_barrier
  s_cmp_lg_u32 s3, 0
  s_cbranch_scc1 L_noq_41
  v_add_u32 v34, 4096, v124
  ds_read_b128 v[48:51], v34 offset:0
  ds_read_b128 v[52:55], v34 offset:2048
  ds_read_b128 v[56:59], v34 offset:4096
  ds_read_b128 v[60:63], v34 offset:6144
  s_waitcnt lgkmcnt(0)
  v_add_f32 v38, v48, v52
  v_add_f32 v35, v56, v60
  v_add_f32 v38, v38, v35
  v_add_f32 v39, v49, v53
  v_add_f32 v35, v57, v61
  v_add_f32 v39, v39, v35
  v_add_f32 v40, v50, v54
  v_add_f32 v35, v58, v62
  v_add_f32 v40, v40, v35
  v_add_f32 v41, v51, v55
  v_add_f32 v35, v59, v63
  v_add_f32 v41, v41, v35
  v_cvt_pk_bf16_f32 v36, v38, v39
  v_cvt_pk_bf16_f32 v37, v40, v41
  s_lshl_b32 s70, s68, 13
  s_lshl_b32 s71, s2, 8
  s_add_u32 s70, s70, s71
  s_add_u32 s70, s70, 8192
  v_lshrrev_b32 v34, 1, v124
  s_mov_b32 exec_hi, 0
  buffer_store_dwordx2 v[36:37], v34, s[36:39], s70 offen sc0 sc1
  s_mov_b32 exec_hi, -1
L_noq_41:
  s_barrier
  s_setpc_b64 s[64:65]
L_stageB:
  s_lshl_b32 s70, s68, 5
  s_add_u32 s70, s70, s2
  s_mul_i32 s70, s70, 17920
  s_add_u32 s72, s70, 589824
  s_mov_b32 s98, 0
L_bpoll_42:
  s_mov_b32 s70, s72
  buffer_load_dwordx4 v[48:51], v113, s[36:39], s70 offen sc1
  buffer_load_dwordx2 v[64:65], v112, s[36:39], s70 offen sc1
  s_add_u32 s70, s70, 5120
  buffer_load_dwordx4 v[52:55], v113, s[36:39], s70 offen sc1
  buffer_load_dwordx2 v[66:67], v112, s[36:39], s70 offen sc1
  s_add_u32 s70, s70, 5120
  buffer_load_dwordx4 v[56:59], v113, s[36:39], s70 offen sc1
  buffer_load_dwordx2 v[68:69], v112, s[36:39], s70 offen sc1
  s_add_u32 s70, s70, 5120
  buffer_load_dwordx4 v[60:63], v114, s[36:39], s70 offen sc1
  buffer_load_dwordx2 v[70:71], v115, s[36:39], s70 offen sc1
  s_waitcnt vmcnt(0)
  v_max_u32 v34, v48, v49
  v_max3_u32 v34, v34, v50, v51
  v_max3_u32 v34, v34, v52, v53
  v_max3_u32 v34, v34, v54, v55
  v_max3_u32 v34, v34, v56, v57
  v_max3_u32 v34, v34, v58, v59
  v_max3_u32 v34, v34, v60, v61
  v_max3_u32 v34, v34, v62, v63
  v_max3_u32 v34, v34, v64, v65
  v_max3_u32 v34, v34, v66, v67
  v_max3_u32 v34, v34, v68, v69
  v_max3_u32 v34, v34, v70, v71
  v_cmp_eq_u32 vcc, -1, v34
  s_nop 4
  s_cbranch_vccz L_bdone_43
  s_add_u32 s98, s98, 1
  s_cmp_gt_u32 s98, 400000
  s_cbranch_scc1 L_bdone_43_to
  s_cmp_lg_u32 s99, 0
  s_cbranch_scc1 L_bdone_43
  s_branch L_bpoll_42
L_bdone_43_to:
  s_mov_b32 s99, 1
L_bdone_43:
  v_mov_b32 v35, 0xff7fffff
  v_cndmask_b32 v70, v35, v70, s[76:77]
  v_max3_f32 v36, v64, v66, v68
  v_max_f32 v36, v36, v70
  s_nop 1
  v_max_f32_dpp v36, v36, v36 row_ror:8 row_mask:0xf bank_mask:0xf
  s_nop 1
  v_max_f32_dpp v36, v36, v36 row_bcast:15 row_mask:0xa bank_mask:0xf
  s_nop 1
  v_max_f32_dpp v36, v36, v36 row_bcast:31 row_mask:0xc bank_mask:0xf
  s_nop 0
  v_readlane_b32 s73, v36, 63
  s_nop 1
  v_subrev_f32 v64, s73, v64
  v_subrev_f32 v66, s73, v66
  v_subrev_f32 v68, s73, v68
  v_subrev_f32 v70, s73, v70
  v_exp_f32 v64, v64
  v_exp_f32 v66, v66
  v_exp_f32 v68, v68
  v_exp_f32 v70, v70
  s_nop 0
  v_cndmask_b32 v70, 0, v70, s[76:77]
  v_mul_f32 v36, v64, v65
  v_fmac_f32 v36, v66, v67
  v_fmac_f32 v36, v68, v69
  v_fmac_f32 v36, v70, v71
  s_nop 1
  v_add_f32_dpp v36, v36, v36 row_ror:8 row_mask:0xf bank_mask:0xf
  s_nop 1
  v_add_f32_dpp v36, v36, v36 row_bcast:15 row_mask:0xa bank_mask:0xf
  s_nop 1
  v_add_f32_dpp v36, v36, v36 row_bcast:31 row_mask:0xc bank_mask:0xf
  s_nop 0
  v_readlane_b32 s74, v36, 63
  v_mul_f32 v38, v64, v48
  v_mul_f32 v39, v64, v49
  v_mul_f32 v40, v64, v50
  v_mul_f32 v41, v64, v51
  v_fmac_f32 v38, v66, v52
  v_fmac_f32 v39, v66, v53
  v_fmac_f32 v40, v66, v54
  v_fmac_f32 v41, v66, v55
  v_fmac_f32 v38, v68, v56
  v_fmac_f32 v39, v68, v57
  v_fmac_f32 v40, v68, v58
  v_fmac_f32 v41, v68, v59
  v_fmac_f32 v38, v70, v60
  v_fmac_f32 v39, v70, v61
  v_fmac_f32 v40, v70, v62
  v_fmac_f32 v41, v70, v63
  v_mov_b32 v36, s74
  v_rcp_f32 v36, v36
  v_add_f32_dpp v38, v38, v38 row_ror:8 row_mask:0xf bank_mask:0xf
  v_add_f32_dpp v39, v39, v39 row_ror:8 row_mask:0xf bank_mask:0xf
  v_add_f32_dpp v40, v40, v40 row_ror:8 row_mask:0xf bank_mask:0xf
  v_add_f32_dpp v41, v41, v41 row_ror:8 row_mask:0xf bank_mask:0xf
  ds_write_b128 v121, v[38:41]
  s_waitcnt lgkmcnt(0)
  ds_read_b32 v42, v122 offset:0
  ds_read_b32 v43, v122 offset:128
  ds_read_b32 v44, v122 offset:256
  ds_read_b32 v45, v122 offset:384
  s_waitcnt lgkmcnt(0)
  v_add_f32 v42, v42, v43
  v_add_f32 v44, v44, v45
  v_add_f32 v42, v42, v44
  v_mul_f32 v42, v42, v36
  v_cvt_pk_bf16_f32 v8, v42, v42
  s_nop 1
  v_and_b32_dpp v10, v8, v4 row_newbcast:0 row_mask:0xf bank_mask:0xf
  v_and_b32_dpp v11, v8, v5 row_newbcast:0 row_mask:0xf bank_mask:0xf
  v_and_b32_dpp v12, v8, v6 row_newbcast:0 row_mask:0xf bank_mask:0xf
  v_and_b32_dpp v13, v8, v7 row_newbcast:0 row_mask:0xf bank_mask:0xf
  v_and_b32_dpp v14, v8, v4 row_newbcast:1 row_mask:0xf bank_mask:0xf
  v_and_b32_dpp v15, v8, v5 row_newbcast:1 row_mask:0xf bank_mask:0xf
  v_and_b32_dpp v16, v8, v6 row_newbcast:1 row_mask:0xf bank_mask:0xf
  v_and_b32_dpp v17, v8, v7 row_newbcast:1 row_mask:0xf bank_mask:0xf
  v_mfma_f32_16x16x32_bf16 v[18:21], v[10:13], a[0:3], 0
  v_mfma_f32_16x16x32_bf16 v[22:25], v[10:13], a[4:7], 0
  v_mfma_f32_16x16x32_bf16 v[26:29], v[10:13], a[8:11], 0
  v_mfma_f32_16x16x32_bf16 v[30:33], v[10:13], a[12:15], 0
  v_and_b32_dpp v10, v8, v4 row_newbcast:2 row_mask:0xf bank_mask:0xf
  v_and_b32_dpp v11, v8, v5 row_newbcast:2 row_mask:0xf bank_mask:0xf
  v_and_b32_dpp v12, v8, v6 row_newbcast:2 row_mask:0xf bank_mask:0xf
  v_and_b32_dpp v13, v8, v7 row_newbcast:2 row_mask:0xf bank_mask:0xf
  v_mfma_f32_16x16x32_bf16 v[18:21], v[14:17], a[16:19], v[18:21]
  v_mfma_f32_16x16x32_bf16 v[22:25], v[14:17], a[20:23], v[22:25]
  v_mfma_f32_16x16x32_bf16 v[26:29], v[14:17], a[24:27], v[26:29]
  v_mfma_f32_16x16x32_bf16 v[30:33], v[14:17], a[28:31], v[30:33]
  v_and_b32_dpp v14, v8, v4 row_newbcast:3 row_mask:0xf bank_mask:0xf
  v_and_b32_dpp v15, v8, v5 row_newbcast:3 row_mask:0xf bank_mask:0xf
  v_and_b32_dpp v16, v8, v6 row_newbcast:3 row_mask:0xf bank_mask:0xf
  v_and_b32_dpp v17, v8, v7 row_newbcast:3 row_mask:0xf bank_mask:0xf
  v_mfma_f32_16x16x32_bf16 v[18:21], v[10:13], a[32:35], v[18:21]
  v_mfma_f32_16x16x32_bf16 v[22:25], v[10:13], a[36:39], v[22:25]
  v_mfma_f32_16x16x32_bf16 v[26:29], v[10:13], a[40:43], v[26:29]
  v_mfma_f32_16x16x32_bf16 v[30:33], v[10:13], a[44:47], v[30:33]
  v_and_b32_dpp v10, v8, v4 row_newbcast:4 row_mask:0xf bank_mask:0xf
  v_and_b32_dpp v11, v8, v5 row_newbcast:4 row_mask:0xf bank_mask:0xf
  v_and_b32_dpp v12, v8, v6 row_newbcast:4 row_mask:0xf bank_mask:0xf
  v_and_b32_dpp v13, v8, v7 row_newbcast:4 row_mask:0xf bank_mask:0xf
  v_mfma_f32_16x16x32_bf16 v[18:21], v[14:17], a[48:51], v[18:21]
  v_mfma_f32_16x16x32_bf16 v[22:25], v[14:17], a[52:55], v[22:25]
  v_mfma_f32_16x16x32_bf16 v[26:29], v[14:17], a[56:59], v[26:29]
  v_mfma_f32_16x16x32_bf16 v[30:33], v[14:17], a[60:63], v[30:33]
  v_and_b32_dpp v14, v8, v4 row_newbcast:5 row_mask:0xf bank_mask:0xf
  v_and_b32_dpp v15, v8, v5 row_newbcast:5 row_mask:0xf bank_mask:0xf
  v_and_b32_dpp v16, v8, v6 row_newbcast:5 row_mask:0xf bank_mask:0xf
  v_and_b32_dpp v17, v8, v7 row_newbcast:5 row_mask:0xf bank_mask:0xf
  v_mfma_f32_16x16x32_bf16 v[18:21], v[10:13], a[64:67], v[18:21]
  v_mfma_f32_16x16x32_bf16 v[22:25], v[10:13], a[68:71], v[22:25]
  v_mfma_f32_16x16x32_bf16 v[26:29], v[10:13], a[72:75], v[26:29]
  v_mfma_f32_16x16x32_bf16 v[30:33], v[10:13], a[76:79], v[30:33]
  v_and_b32_dpp v10, v8, v4 row_newbcast:6 row_mask:0xf bank_mask:0xf
  v_and_b32_dpp v11, v8, v5 row_newbcast:6 row_mask:0xf bank_mask:0xf
  v_and_b32_dpp v12, v8, v6 row_newbcast:6 row_mask:0xf bank_mask:0xf
  v_and_b32_dpp v13, v8, v7 row_newbcast:6 row_mask:0xf bank_mask:0xf
  v_mfma_f32_16x16x32_bf16 v[18:21], v[14:17], a[80:83], v[18:21]
  v_mfma_f32_16x16x32_bf16 v[22:25], v[14:17], a[84:87], v[22:25]
  v_mfma_f32_16x16x32_bf16 v[26:29], v[14:17], a[88:91], v[26:29]
  v_mfma_f32_16x16x32_bf16 v[30:33], v[14:17], a[92:95], v[30:33]
  v_and_b32_dpp v14, v8, v4 row_newbcast:7 row_mask:0xf bank_mask:0xf
  v_and_b32_dpp v15, v8, v5 row_newbcast:7 row_mask:0xf bank_mask:0xf
  v_and_b32_dpp v16, v8, v6 row_newbcast:7 row_mask:0xf bank_mask:0xf
  v_and_b32_dpp v17, v8, v7 row_newbcast:7 row_mask:0xf bank_mask:0xf
  v_mfma_f32_16x16x32_bf16 v[18:21], v[10:13], a[96:99], v[18:21]
  v_mfma_f32_16x16x32_bf16 v[22:25], v[10:13], a[100:103], v[22:25]
  v_mfma_f32_16x16x32_bf16 v[26:29], v[10:13], a[104:107], v[26:29]
  v_mfma_f32_16x16x32_bf16 v[30:33], v[10:13], a[108:111], v[30:33]
  s_nop 0
  v_mfma_f32_16x16x32_bf16 v[18:21], v[14:17], a[112:115], v[18:21]
  v_mfma_f32_16x16x32_bf16 v[22:25], v[14:17], a[116:119], v[22:25]
  v_mfma_f32_16x16x32_bf16 v[26:29], v[14:17], a[120:123], v[26:29]
  v_mfma_f32_16x16x32_bf16 v[30:33], v[14:17], a[124:127], v[30:33]
  s_nop 7
  s_lshl_b32 s70, s3, 11
  s_add_u32 s70, s70, 4096
  v_add_u32 v34, s70, v116
  s_mov_b32 exec_hi, 0
  ds_write_b128 v34, v[18:21] offset:0
  ds_write_b128 v34, v[22:25] offset:512
  ds_write_b128 v34, v[26:29] offset:1024
  ds_write_b128 v34, v[30:33] offset:1536
  s_mov_b32 exec_hi, -1
  s_waitcnt lgkmcnt(0)
  s_barrier
  v_add_u32 v34, 4096, v118
  ds_read_b128 v[48:51], v34 offset:0
  ds_read_b128 v[52:55], v34 offset:2048
  ds_read_b128 v[56:59], v34 offset:4096
  ds_read_b128 v[60:63], v34 offset:6144
  s_waitcnt lgkmcnt(0)
  v_add_f32 v38, v48, v52
  v_add_f32 v35, v56, v60
  v_add_f32 v38, v38, v35
  v_add_f32 v39, v49, v53
  v_add_f32 v35, v57, v61
  v_add_f32 v39, v39, v35
  v_add_f32 v40, v50, v54
  v_add_f32 v35, v58, v62
  v_add_f32 v40, v40, v35
  v_add_f32 v41, v51, v55
  v_add_f32 v35, v59, v63
  v_add_f32 v41, v41, v35
  s_lshl_b32 s70, s68, 16
  s_lshl_b32 s71, s2, 11
  s_add_u32 s70, s70, s71
  s_add_u32 s70, s70, 40960
  s_mov_b32 exec_hi, 0
  buffer_store_dwordx4 v[38:41], v118, s[36:39], s70 offen sc0 sc1
  s_mov_b32 exec_hi, -1
  s_setpc_b64 s[64:65]
L_stageD1:
  s_lshl_b32 s72, s68, 16
  s_add_u32 s72, s72, 40960
  s_mov_b32 s98, 0
L_dpoll_44:
  s_mov_b32 s70, s72
  buffer_load_dwordx4 v[48:51], v117, s[36:39], s70 offen sc1
  s_add_u32 s70, s70, 4096
  buffer_load_dwordx4 v[52:55], v117, s[36:39], s70 offen sc1
  s_add_u32 s70, s70, 4096
  buffer_load_dwordx4 v[56:59], v117, s[36:39], s70 offen sc1
  s_add_u32 s70, s70, 4096
  buffer_load_dwordx4 v[60:63], v117, s[36:39], s70 offen sc1
  s_add_u32 s70, s70, 4096
  buffer_load_dwordx4 v[64:67], v117, s[36:39], s70 offen sc1
  s_add_u32 s70, s70, 4096
  buffer_load_dwordx4 v[68:71], v117, s[36:39], s70 offen sc1
  s_add_u32 s70, s70, 4096
  buffer_load_dwordx4 v[72:75], v117, s[36:39], s70 offen sc1
  s_add_u32 s70, s70, 4096
  buffer_load_dwordx4 v[76:79], v117, s[36:39], s70 offen sc1
  s_add_u32 s70, s70, 4096
  buffer_load_dwordx4 v[80:83], v117, s[36:39], s70 offen sc1
  s_add_u32 s70, s70, 4096
  buffer_load_dwordx4 v[84:87], v117, s[36:39], s70 offen sc1
  s_add_u32 s70, s70, 4096
  buffer_load_dwordx4 v[88:91], v117, s[36:39], s70 offen sc1
  s_add_u32 s70, s70, 4096
  buffer_load_dwordx4 v[92:95], v117, s[36:39], s70 offen sc1
  s_add_u32 s70, s70, 4096
  buffer_load_dwordx4 v[96:99], v117, s[36:39], s70 offen sc1
  s_add_u32 s70, s70, 4096
  buffer_load_dwordx4 v[100:103], v117, s[36:39], s70 offen sc1
  s_add_u32 s70, s70, 4096
  buffer_load_dwordx4 v[104:107], v117, s[36:39], s70 offen sc1
  s_add_u32 s70, s70, 4096
  buffer_load_dwordx4 v[108:111], v117, s[36:39], s70 offen sc1
  s_waitcnt vmcnt(0)
  v_max_u32 v34, v48, v49
  v_max3_u32 v34, v34, v50, v51
  v_max3_u32 v34, v34, v52, v53
  v_max3_u32 v34, v34, v54, v55
  v_max3_u32 v34, v34, v56, v57
  v_max3_u32 v34, v34, v58, v59
  v_max3_u32 v34, v34, v60, v61
  v_max3_u32 v34, v34, v62, v63
  v_max3_u32 v34, v34, v64, v65
  v_max3_u32 v34, v34, v66, v67
  v_max3_u32 v34, v34, v68, v69
  v_max3_u32 v34, v34, v70, v71
  v_max3_u32 v34, v34, v72, v73
  v_max3_u32 v34, v34, v74, v75
  v_max3_u32 v34, v34, v76, v77
  v_max3_u32 v34, v34, v78, v79
  v_max3_u32 v34, v34, v80, v81
  v_max3_u32 v34, v34, v82, v83
  v_max3_u32 v34, v34, v84, v85
  v_max3_u32 v34, v34, v86, v87
  v_max3_u32 v34, v34, v88, v89
  v_max3_u32 v34, v34, v90, v91
  v_max3_u32 v34, v34, v92, v93
  v_max3_u32 v34, v34, v94, v95
  v_max3_u32 v34, v34, v96, v97
  v_max3_u32 v34, v34, v98, v99
  v_max3_u32 v34, v34, v100, v101
  v_max3_u32 v34, v34, v102, v103
  v_max3_u32 v34, v34, v104, v105
  v_max3_u32 v34, v34, v106, v107
  v_max3_u32 v34, v34, v108, v109
  v_max3_u32 v34, v34, v110, v111
  v_cmp_eq_u32 vcc, -1, v34
  s_nop 4
  s_cbranch_vccz L_dpolld_45
  s_add_u32 s98, s98, 1
  s_cmp_gt_u32 s98, 400000
  s_cbranch_scc1 L_dpolld_45_to
  s_cmp_lg_u32 s99, 0
  s_cbranch_scc1 L_dpolld_45
  s_branch L_dpoll_44
L_dpolld_45_to:
  s_mov_b32 s99, 1
L_dpolld_45:
  v_add_u32 v34, s69, v118
  ds_read_b128 v[42:45], v34
  v_add_f32 v38, v48, v52
  v_add_f32 v39, v49, v53
  v_add_f32 v40, v50, v54
  v_add_f32 v41, v51, v55
  v_add_f32 v38, v38, v56
  v_add_f32 v39, v39, v57
  v_add_f32 v40, v40, v58
  v_add_f32 v41, v41, v59
  v_add_f32 v38, v38, v60
  v_add_f32 v39, v39, v61
  v_add_f32 v40, v40, v62
  v_add_f32 v41, v41, v63
  v_add_f32 v38, v38, v64
  v_add_f32 v39, v39, v65
  v_add_f32 v40, v40, v66
  v_add_f32 v41, v41, v67
  v_add_f32 v38, v38, v68
  v_add_f32 v39, v39, v69
  v_add_f32 v40, v40, v70
  v_add_f32 v41, v41, v71
  v_add_f32 v38, v38, v72
  v_add_f32 v39, v39, v73
  v_add_f32 v40, v40, v74
  v_add_f32 v41, v41, v75
  v_add_f32 v38, v38, v76
  v_add_f32 v39, v39, v77
  v_add_f32 v40, v40, v78
  v_add_f32 v41, v41, v79
  v_add_f32 v38, v38, v80
  v_add_f32 v39, v39, v81
  v_add_f32 v40, v40, v82
  v_add_f32 v41, v41, v83
  v_add_f32 v38, v38, v84
  v_add_f32 v39, v39, v85
  v_add_f32 v40, v40, v86
  v_add_f32 v41, v41, v87
  v_add_f32 v38, v38, v88
  v_add_f32 v39, v39, v89
  v_add_f32 v40, v40, v90
  v_add_f32 v41, v41, v91
  v_add_f32 v38, v38, v92
  v_add_f32 v39, v39, v93
  v_add_f32 v40, v40, v94
  v_add_f32 v41, v41, v95
  v_add_f32 v38, v38, v96
  v_add_f32 v39, v39, v97
  v_add_f32 v40, v40, v98
  v_add_f32 v41, v41, v99
  v_add_f32 v38, v38, v100
  v_add_f32 v39, v39, v101
  v_add_f32 v40, v40, v102
  v_add_f32 v41, v41, v103
  v_add_f32 v38, v38, v104
  v_add_f32 v39, v39, v105
  v_add_f32 v40, v40, v106
  v_add_f32 v41, v41, v107
  v_add_f32 v38, v38, v108
  v_add_f32 v39, v39, v109
  v_add_f32 v40, v40, v110
  v_add_f32 v41, v41, v111
  v_mov_b32 v10, v38
  v_mov_b32 v11, v39
  v_mov_b32 v12, v40
  v_mov_b32 v13, v41
  s_nop 1
  v_permlane32_swap_b32 v38, v10
  v_permlane32_swap_b32 v39, v11
  v_permlane32_swap_b32 v40, v12
  v_permlane32_swap_b32 v41, v13
  s_nop 1
  v_add_f32 v38, v38, v10
  v_cvt_pk_bf16_f32 v38, v38, v38
  v_and_b32 v38, 0xffff0000, v38
  v_add_f32 v39, v39, v11
  v_cvt_pk_bf16_f32 v39, v39, v39
  v_and_b32 v39, 0xffff0000, v39
  v_add_f32 v40, v40, v12
  v_cvt_pk_bf16_f32 v40, v40, v40
  v_and_b32 v40, 0xffff0000, v40
  v_add_f32 v41, v41, v13
  v_cvt_pk_bf16_f32 v41, v41, v41
  v_and_b32 v41, 0xffff0000, v41
  s_waitcnt lgkmcnt(0)
  v_add_f32 v38, v38, v42
  v_cvt_pk_bf16_f32 v38, v38, v38
  v_and_b32 v38, 0xffff0000, v38
  v_add_f32 v39, v39, v43
  v_cvt_pk_bf16_f32 v39, v39, v39
  v_and_b32 v39, 0xffff0000, v39
  v_add_f32 v40, v40, v44
  v_cvt_pk_bf16_f32 v40, v40, v40
  v_and_b32 v40, 0xffff0000, v40
  v_add_f32 v41, v41, v45
  v_cvt_pk_bf16_f32 v41, v41, v41
  v_and_b32 v41, 0xffff0000, v41
  ds_write_b128 v34, v[38:41]
  s_waitcnt lgkmcnt(0)
  s_barrier
  s_setpc_b64 s[64:65]
L_stageD2:
  v_add_u32 v34, s69, v120
  ds_read_b128 v[48:51], v34
  ds_read_b128 v[52:55], v34 offset:16
  s_lshl_b32 s70, s3, 9
  s_add_u32 s70, s70, s69
  v_add_u32 v35, s70, v119
  ds_read_b32 v8, v35
  ds_read_b32 v9, v35 offset:256
  s_waitcnt lgkmcnt(0)
  v_add_f32 v36, v48, v49
  v_add_f32 v36, v36, v50
  v_add_f32 v36, v36, v51
  v_add_f32 v36, v36, v52
  v_add_f32 v36, v36, v53
  v_add_f32 v36, v36, v54
  v_add_f32 v36, v36, v55
  s_nop 1
  v_add_f32_dpp v36, v36, v36 row_ror:1 row_mask:0xf bank_mask:0xf
  s_nop 1
  v_add_f32_dpp v36, v36, v36 row_ror:2 row_mask:0xf bank_mask:0xf
  s_nop 1
  v_add_f32_dpp v36, v36, v36 row_ror:4 row_mask:0xf bank_mask:0xf
  s_nop 1
  v_add_f32_dpp v36, v36, v36 row_ror:8 row_mask:0xf bank_mask:0xf
  s_nop 1
  v_add_f32_dpp v36, v36, v36 row_bcast:15 row_mask:0xa bank_mask:0xf
  s_nop 1
  v_add_f32_dpp v36, v36, v36 row_bcast:31 row_mask:0xc bank_mask:0xf
  s_nop 0
  v_readlane_b32 s73, v36, 63
  s_nop 1
  v_mov_b32 v37, s73
  v_mul_f32 v37, 0x3b000000, v37
  v_sub_f32 v38, v48, v37
  v_mul_f32 v36, v38, v38
  v_sub_f32 v38, v49, v37
  v_fmac_f32 v36, v38, v38
  v_sub_f32 v38, v50, v37
  v_fmac_f32 v36, v38, v38
  v_sub_f32 v38, v51, v37
  v_fmac_f32 v36, v38, v38
  v_sub_f32 v38, v52, v37
  v_fmac_f32 v36, v38, v38
  v_sub_f32 v38, v53, v37
  v_fmac_f32 v36, v38, v38
  v_sub_f32 v38, v54, v37
  v_fmac_f32 v36, v38, v38
  v_sub_f32 v38, v55, v37
  v_fmac_f32 v36, v38, v38
  s_nop 1
  v_add_f32_dpp v36, v36, v36 row_ror:1 row_mask:0xf bank_mask:0xf
  s_nop 1
  v_add_f32_dpp v36, v36, v36 row_ror:2 row_mask:0xf bank_mask:0xf
  s_nop 1
  v_add_f32_dpp v36, v36, v36 row_ror:4 row_mask:0xf bank_mask:0xf
  s_nop 1
  v_add_f32_dpp v36, v36, v36 row_ror:8 row_mask:0xf bank_mask:0xf
  s_nop 1
  v_add_f32_dpp v36, v36, v36 row_bcast:15 row_mask:0xa bank_mask:0xf
  s_nop 1
  v_add_f32_dpp v36, v36, v36 row_bcast:31 row_mask:0xc bank_mask:0xf
  s_nop 0
  v_readlane_b32 s74, v36, 63
  s_nop 1
  v_mov_b32 v38, s74
  v_mul_f32 v38, 0x3b000000, v38
  v_cvt_pk_bf16_f32 v38, v38, v38
  v_and_b32 v38, 0xffff0000, v38
  v_add_f32 v38, 0x3727c5ac, v38
  v_cvt_pk_bf16_f32 v38, v38, v38
  v_and_b32 v38, 0xffff0000, v38
  v_sqrt_f32 v38, v38
  s_nop 0
  v_cvt_pk_bf16_f32 v38, v38, v38
  v_and_b32 v38, 0xffff0000, v38
  v_rcp_f32 v38, v38
  v_cvt_pk_bf16_f32 v37, v37, v37
  v_and_b32 v37, 0xffff0000, v37
  v_sub_f32 v8, v8, v37
  v_cvt_pk_bf16_f32 v8, v8, v8
  v_and_b32 v8, 0xffff0000, v8
  v_mul_f32 v8, v8, v38
  v_cvt_pk_bf16_f32 v8, v8, v8
  v_sub_f32 v9, v9, v37
  v_cvt_pk_bf16_f32 v9, v9, v9
  v_and_b32 v9, 0xffff0000, v9
  v_mul_f32 v9, v9, v38
  v_cvt_pk_bf16_f32 v9, v9, v9
  s_lshl_b32 s70, s3, 14
  s_add_u32 s70, s70, 16384
  v_lshlrev_b32 v34, 4, v0
  v_add_u32 v34, s70, v34
  ds_read_b128 v[48:51], v34 offset:0
  ds_read_b128 v[52:55], v34 offset:1024
  ds_read_b128 v[56:59], v34 offset:2048
  ds_read_b128 v[60:63], v34 offset:3072
  ds_read_b128 v[64:67], v34 offset:4096
  ds_read_b128 v[68:71], v34 offset:5120
  ds_read_b128 v[72:75], v34 offset:6144
  ds_read_b128 v[76:79], v34 offset:7168
  ds_read_b128 v[80:83], v34 offset:8192
  ds_read_b128 v[84:87], v34 offset:9216
  ds_read_b128 v[88:91], v34 offset:10240
  ds_read_b128 v[92:95], v34 offset:11264
  ds_read_b128 v[96:99], v34 offset:12288
  ds_read_b128 v[100:103], v34 offset:13312
  ds_read_b128 v[104:107], v34 offset:14336
  ds_read_b128 v[108:111], v34 offset:15360
  s_nop 1
  v_and_b32_dpp v10, v8, v4 row_newbcast:0 row_mask:0xf bank_mask:0xf
  v_and_b32_dpp v11, v8, v5 row_newbcast:0 row_mask:0xf bank_mask:0xf
  v_and_b32_dpp v12, v8, v6 row_newbcast:0 row_mask:0xf bank_mask:0xf
  v_and_b32_dpp v13, v8, v7 row_newbcast:0 row_mask:0xf bank_mask:0xf
  v_and_b32_dpp v14, v8, v4 row_newbcast:1 row_mask:0xf bank_mask:0xf
  v_and_b32_dpp v15, v8, v5 row_newbcast:1 row_mask:0xf bank_mask:0xf
  v_and_b32_dpp v16, v8, v6 row_newbcast:1 row_mask:0xf bank_mask:0xf
  v_and_b32_dpp v17, v8, v7 row_newbcast:1 row_mask:0xf bank_mask:0xf
  v_mfma_f32_16x16x32_bf16 v[18:21], v[10:13], v[128:131], 0
  v_and_b32_dpp v10, v8, v4 row_newbcast:2 row_mask:0xf bank_mask:0xf
  v_and_b32_dpp v11, v8, v5 row_newbcast:2 row_mask:0xf bank_mask:0xf
  v_and_b32_dpp v12, v8, v6 row_newbcast:2 row_mask:0xf bank_mask:0xf
  v_and_b32_dpp v13, v8, v7 row_newbcast:2 row_mask:0xf bank_mask:0xf
  v_mfma_f32_16x16x32_bf16 v[18:21], v[14:17], v[132:135], v[18:21]
  v_and_b32_dpp v14, v8, v4 row_newbcast:3 row_mask:0xf bank_mask:0xf
  v_and_b32_dpp v15, v8, v5 row_newbcast:3 row_mask:0xf bank_mask:0xf
  v_and_b32_dpp v16, v8, v6 row_newbcast:3 row_mask:0xf bank_mask:0xf
  v_and_b32_dpp v17, v8, v7 row_newbcast:3 row_mask:0xf bank_mask:0xf
  v_mfma_f32_16x16x32_bf16 v[18:21], v[10:13], v[136:139], v[18:21]
  v_and_b32_dpp v10, v8, v4 row_newbcast:4 row_mask:0xf bank_mask:0xf
  v_and_b32_dpp v11, v8, v5 row_newbcast:4 row_mask:0xf bank_mask:0xf
  v_and_b32_dpp v12, v8, v6 row_newbcast:4 row_mask:0xf bank_mask:0xf
  v_and_b32_dpp v13, v8, v7 row_newbcast:4 row_mask:0xf bank_mask:0xf
  v_mfma_f32_16x16x32_bf16 v[18:21], v[14:17], v[140:143], v[18:21]
  v_and_b32_dpp v14, v8, v4 row_newbcast:5 row_mask:0xf bank_mask:0xf
  v_and_b32_dpp v15, v8, v5 row_newbcast:5 row_mask:0xf bank_mask:0xf
  v_and_b32_dpp v16, v8, v6 row_newbcast:5 row_mask:0xf bank_mask:0xf
  v_and_b32_dpp v17, v8, v7 row_newbcast:5 row_mask:0xf bank_mask:0xf
  v_mfma_f32_16x16x32_bf16 v[18:21], v[10:13], v[144:147], v[18:21]
  v_and_b32_dpp v10, v8, v4 row_newbcast:6 row_mask:0xf bank_mask:0xf
  v_and_b32_dpp v11, v8, v5 row_newbcast:6 row_mask:0xf bank_mask:0xf
  v_and_b32_dpp v12, v8, v6 row_newbcast:6 row_mask:0xf bank_mask:0xf
  v_and_b32_dpp v13, v8, v7 row_newbcast:6 row_mask:0xf bank_mask:0xf
  v_mfma_f32_16x16x32_bf16 v[18:21], v[14:17], v[148:151], v[18:21]
  v_and_b32_dpp v14, v8, v4 row_newbcast:7 row_mask:0xf bank_mask:0xf
  v_and_b32_dpp v15, v8, v5 row_newbcast:7 row_mask:0xf bank_mask:0xf
  v_and_b32_dpp v16, v8, v6 row_newbcast:7 row_mask:0xf bank_mask:0xf
  v_and_b32_dpp v17, v8, v7 row_newbcast:7 row_mask:0xf bank_mask:0xf
  v_mfma_f32_16x16x32_bf16 v[18:21], v[10:13], v[152:155], v[18:21]
  v_and_b32_dpp v10, v8, v4 row_newbcast:8 row_mask:0xf bank_mask:0xf
  v_and_b32_dpp v11, v8, v5 row_newbcast:8 row_mask:0xf bank_mask:0xf
  v_and_b32_dpp v12, v8, v6 row_newbcast:8 row_mask:0xf bank_mask:0xf
  v_and_b32_dpp v13, v8, v7 row_newbcast:8 row_mask:0xf bank_mask:0xf
  v_mfma_f32_16x16x32_bf16 v[18:21], v[14:17], v[156:159], v[18:21]
  v_and_b32_dpp v14, v8, v4 row_newbcast:9 row_mask:0xf bank_mask:0xf
  v_and_b32_dpp v15, v8, v5 row_newbcast:9 row_mask:0xf bank_mask:0xf
  v_and_b32_dpp v16, v8, v6 row_newbcast:9 row_mask:0xf bank_mask:0xf
  v_and_b32_dpp v17, v8, v7 row_newbcast:9 row_mask:0xf bank_mask:0xf
  v_mfma_f32_16x16x32_bf16 v[18:21], v[10:13], v[160:163], v[18:21]
  v_and_b32_dpp v10, v8, v4 row_newbcast:10 row_mask:0xf bank_mask:0xf
  v_and_b32_dpp v11, v8, v5 row_newbcast:10 row_mask:0xf bank_mask:0xf
  v_and_b32_dpp v12, v8, v6 row_newbcast:10 row_mask:0xf bank_mask:0xf
  v_and_b32_dpp v13, v8, v7 row_newbcast:10 row_mask:0xf bank_mask:0xf
  v_mfma_f32_16x16x32_bf16 v[18:21], v[14:17], v[164:167], v[18:21]
  v_and_b32_dpp v14, v8, v4 row_newbcast:11 row_mask:0xf bank_mask:0xf
  v_and_b32_dpp v15, v8, v5 row_newbcast:11 row_mask:0xf bank_mask:0xf
  v_and_b32_dpp v16, v8, v6 row_newbcast:11 row_mask:0xf bank_mask:0xf
  v_and_b32_dpp v17, v8, v7 row_newbcast:11 row_mask:0xf bank_mask:0xf
  v_mfma_f32_16x16x32_bf16 v[18:21], v[10:13], v[168:171], v[18:21]
  v_and_b32_dpp v10, v8, v4 row_newbcast:12 row_mask:0xf bank_mask:0xf
  v_and_b32_dpp v11, v8, v5 row_newbcast:12 row_mask:0xf bank_mask:0xf
  v_and_b32_dpp v12, v8, v6 row_newbcast:12 row_mask:0xf bank_mask:0xf
  v_and_b32_dpp v13, v8, v7 row_newbcast:12 row_mask:0xf bank_mask:0xf
  v_mfma_f32_16x16x32_bf16 v[18:21], v[14:17], v[172:175], v[18:21]
  v_and_b32_dpp v14, v8, v4 row_newbcast:13 row_mask:0xf bank_mask:0xf
  v_and_b32_dpp v15, v8, v5 row_newbcast:13 row_mask:0xf bank_mask:0xf
  v_and_b32_dpp v16, v8, v6 row_newbcast:13 row_mask:0xf bank_mask:0xf
  v_and_b32_dpp v17, v8, v7 row_newbcast:13 row_mask:0xf bank_mask:0xf
  v_mfma_f32_16x16x32_bf16 v[18:21], v[10:13], v[176:179], v[18:21]
  v_and_b32_dpp v10, v8, v4 row_newbcast:14 row_mask:0xf bank_mask:0xf
  v_and_b32_dpp v11, v8, v5 row_newbcast:14 row_mask:0xf bank_mask:0xf
  v_and_b32_dpp v12, v8, v6 row_newbcast:14 row_mask:0xf bank_mask:0xf
  v_and_b32_dpp v13, v8, v7 row_newbcast:14 row_mask:0xf bank_mask:0xf
  v_mfma_f32_16x16x32_bf16 v[18:21], v[14:17], v[180:183], v[18:21]
  v_and_b32_dpp v14, v8, v4 row_newbcast:15 row_mask:0xf bank_mask:0xf
  v_and_b32_dpp v15, v8, v5 row_newbcast:15 row_mask:0xf bank_mask:0xf
  v_and_b32_dpp v16, v8, v6 row_newbcast:15 row_mask:0xf bank_mask:0xf
  v_and_b32_dpp v17, v8, v7 row_newbcast:15 row_mask:0xf bank_mask:0xf
  v_mfma_f32_16x16x32_bf16 v[18:21], v[10:13], v[184:187], v[18:21]
  v_and_b32_dpp v10, v9, v4 row_newbcast:0 row_mask:0xf bank_mask:0xf
  v_and_b32_dpp v11, v9, v5 row_newbcast:0 row_mask:0xf bank_mask:0xf
  v_and_b32_dpp v12, v9, v6 row_newbcast:0 row_mask:0xf bank_mask:0xf
  v_and_b32_dpp v13, v9, v7 row_newbcast:0 row_mask:0xf bank_mask:0xf
  v_mfma_f32_16x16x32_bf16 v[18:21], v[14:17], v[188:191], v[18:21]
  v_and_b32_dpp v14, v9, v4 row_newbcast:1 row_mask:0xf bank_mask:0xf
  v_and_b32_dpp v15, v9, v5 row_newbcast:1 row_mask:0xf bank_mask:0xf
  v_and_b32_dpp v16, v9, v6 row_newbcast:1 row_mask:0xf bank_mask:0xf
  v_and_b32_dpp v17, v9, v7 row_newbcast:1 row_mask:0xf bank_mask:0xf
  v_mfma_f32_16x16x32_bf16 v[18:21], v[10:13], v[192:195], v[18:21]
  v_and_b32_dpp v10, v9, v4 row_newbcast:2 row_mask:0xf bank_mask:0xf
  v_and_b32_dpp v11, v9, v5 row_newbcast:2 row_mask:0xf bank_mask:0xf
  v_and_b32_dpp v12, v9, v6 row_newbcast:2 row_mask:0xf bank_mask:0xf
  v_and_b32_dpp v13, v9, v7 row_newbcast:2 row_mask:0xf bank_mask:0xf
  v_mfma_f32_16x16x32_bf16 v[18:21], v[14:17], v[196:199], v[18:21]
  v_and_b32_dpp v14, v9, v4 row_newbcast:3 row_mask:0xf bank_mask:0xf
  v_and_b32_dpp v15, v9, v5 row_newbcast:3 row_mask:0xf bank_mask:0xf
  v_and_b32_dpp v16, v9, v6 row_newbcast:3 row_mask:0xf bank_mask:0xf
  v_and_b32_dpp v17, v9, v7 row_newbcast:3 row_mask:0xf bank_mask:0xf
  v_mfma_f32_16x16x32_bf16 v[18:21], v[10:13], v[200:203], v[18:21]
  v_and_b32_dpp v10, v9, v4 row_newbcast:4 row_mask:0xf bank_mask:0xf
  v_and_b32_dpp v11, v9, v5 row_newbcast:4 row_mask:0xf bank_mask:0xf
  v_and_b32_dpp v12, v9, v6 row_newbcast:4 row_mask:0xf bank_mask:0xf
  v_and_b32_dpp v13, v9, v7 row_newbcast:4 row_mask:0xf bank_mask:0xf
  v_mfma_f32_16x16x32_bf16 v[18:21], v[14:17], v[204:207], v[18:21]
  v_and_b32_dpp v14, v9, v4 row_newbcast:5 row_mask:0xf bank_mask:0xf
  v_and_b32_dpp v15, v9, v5 row_newbcast:5 row_mask:0xf bank_mask:0xf
  v_and_b32_dpp v16, v9, v6 row_newbcast:5 row_mask:0xf bank_mask:0xf
  v_and_b32_dpp v17, v9, v7 row_newbcast:5 row_mask:0xf bank_mask:0xf
  v_mfma_f32_16x16x32_bf16 v[18:21], v[10:13], v[208:211], v[18:21]
  v_and_b32_dpp v10, v9, v4 row_newbcast:6 row_mask:0xf bank_mask:0xf
  v_and_b32_dpp v11, v9, v5 row_newbcast:6 row_mask:0xf bank_mask:0xf
  v_and_b32_dpp v12, v9, v6 row_newbcast:6 row_mask:0xf bank_mask:0xf
  v_and_b32_dpp v13, v9, v7 row_newbcast:6 row_mask:0xf bank_mask:0xf
  v_mfma_f32_16x16x32_bf16 v[18:21], v[14:17], v[212:215], v[18:21]
  v_and_b32_dpp v14, v9, v4 row_newbcast:7 row_mask:0xf bank_mask:0xf
  v_and_b32_dpp v15, v9, v5 row_newbcast:7 row_mask:0xf bank_mask:0xf
  v_and_b32_dpp v16, v9, v6 row_newbcast:7 row_mask:0xf bank_mask:0xf
  v_and_b32_dpp v17, v9, v7 row_newbcast:7 row_mask:0xf bank_mask:0xf
  v_mfma_f32_16x16x32_bf16 v[18:21], v[10:13], v[216:219], v[18:21]
  v_and_b32_dpp v10, v9, v4 row_newbcast:8 row_mask:0xf bank_mask:0xf
  v_and_b32_dpp v11, v9, v5 row_newbcast:8 row_mask:0xf bank_mask:0xf
  v_and_b32_dpp v12, v9, v6 row_newbcast:8 row_mask:0xf bank_mask:0xf
  v_and_b32_dpp v13, v9, v7 row_newbcast:8 row_mask:0xf bank_mask:0xf
  v_mfma_f32_16x16x32_bf16 v[18:21], v[14:17], v[220:223], v[18:21]
  v_and_b32_dpp v14, v9, v4 row_newbcast:9 row_mask:0xf bank_mask:0xf
  v_and_b32_dpp v15, v9, v5 row_newbcast:9 row_mask:0xf bank_mask:0xf
  v_and_b32_dpp v16, v9, v6 row_newbcast:9 row_mask:0xf bank_mask:0xf
  v_and_b32_dpp v17, v9, v7 row_newbcast:9 row_mask:0xf bank_mask:0xf
  v_mfma_f32_16x16x32_bf16 v[18:21], v[10:13], v[224:227], v[18:21]
  v_and_b32_dpp v10, v9, v4 row_newbcast:10 row_mask:0xf bank_mask:0xf
  v_and_b32_dpp v11, v9, v5 row_newbcast:10 row_mask:0xf bank_mask:0xf
  v_and_b32_dpp v12, v9, v6 row_newbcast:10 row_mask:0xf bank_mask:0xf
  v_and_b32_dpp v13, v9, v7 row_newbcast:10 row_mask:0xf bank_mask:0xf
  v_mfma_f32_16x16x32_bf16 v[18:21], v[14:17], v[228:231], v[18:21]
  v_and_b32_dpp v14, v9, v4 row_newbcast:11 row_mask:0xf bank_mask:0xf
  v_and_b32_dpp v15, v9, v5 row_newbcast:11 row_mask:0xf bank_mask:0xf
  v_and_b32_dpp v16, v9, v6 row_newbcast:11 row_mask:0xf bank_mask:0xf
  v_and_b32_dpp v17, v9, v7 row_newbcast:11 row_mask:0xf bank_mask:0xf
  v_mfma_f32_16x16x32_bf16 v[18:21], v[10:13], v[232:235], v[18:21]
  v_and_b32_dpp v10, v9, v4 row_newbcast:12 row_mask:0xf bank_mask:0xf
  v_and_b32_dpp v11, v9, v5 row_newbcast:12 row_mask:0xf bank_mask:0xf
  v_and_b32_dpp v12, v9, v6 row_newbcast:12 row_mask:0xf bank_mask:0xf
  v_and_b32_dpp v13, v9, v7 row_newbcast:12 row_mask:0xf bank_mask:0xf
  v_mfma_f32_16x16x32_bf16 v[18:21], v[14:17], v[236:239], v[18:21]
  v_and_b32_dpp v14, v9, v4 row_newbcast:13 row_mask:0xf bank_mask:0xf
  v_and_b32_dpp v15, v9, v5 row_newbcast:13 row_mask:0xf bank_mask:0xf
  v_and_b32_dpp v16, v9, v6 row_newbcast:13 row_mask:0xf bank_mask:0xf
  v_and_b32_dpp v17, v9, v7 row_newbcast:13 row_mask:0xf bank_mask:0xf
  v_mfma_f32_16x16x32_bf16 v[18:21], v[10:13], v[240:243], v[18:21]
  v_and_b32_dpp v10, v9, v4 row_newbcast:14 row_mask:0xf bank_mask:0xf
  v_and_b32_dpp v11, v9, v5 row_newbcast:14 row_mask:0xf bank_mask:0xf
  v_and_b32_dpp v12, v9, v6 row_newbcast:14 row_mask:0xf bank_mask:0xf
  v_and_b32_dpp v13, v9, v7 row_newbcast:14 row_mask:0xf bank_mask:0xf
  v_mfma_f32_16x16x32_bf16 v[18:21], v[14:17], v[244:247], v[18:21]
  v_and_b32_dpp v14, v9, v4 row_newbcast:15 row_mask:0xf bank_mask:0xf
  v_and_b32_dpp v15, v9, v5 row_newbcast:15 row_mask:0xf bank_mask:0xf
  v_and_b32_dpp v16, v9, v6 row_newbcast:15 row_mask:0xf bank_mask:0xf
  v_and_b32_dpp v17, v9, v7 row_newbcast:15 row_mask:0xf bank_mask:0xf
  v_mfma_f32_16x16x32_bf16 v[18:21], v[10:13], v[248:251], v[18:21]
  s_nop 0
  v_mfma_f32_16x16x32_bf16 v[18:21], v[14:17], v[252:255], v[18:21]
  s_nop 7
  s_lshl_b32 s70, s3, 9
  s_add_u32 s70, s70, 14336
  v_add_u32 v34, s70, v116
  s_mov_b32 exec_hi, 0
  ds_write_b128 v34, v[18:21]
  s_mov_b32 exec_hi, -1
  s_waitcnt lgkmcnt(0)
  s_barrier
  s_lshl_b32 s70, s3, 6
  s_add_u32 s70, s70, 14336
  v_add_u32 v34, s70, v119
  ds_read_b32 v36, v34 offset:0
  ds_read_b32 v40, v34 offset:256
  ds_read_b32 v37, v34 offset:512
  ds_read_b32 v41, v34 offset:768
  ds_read_b32 v38, v34 offset:1024
  ds_read_b32 v42, v34 offset:1280
  ds_read_b32 v39, v34 offset:1536
  ds_read_b32 v43, v34 offset:1792
  s_waitcnt lgkmcnt(0)
  v_add_f32 v36, v36, v37
  v_add_f32 v38, v38, v39
  v_add_f32 v36, v36, v38
  v_cvt_pk_bf16_f32 v36, v36, v36
  v_and_b32 v36, 0xffff0000, v36
  v_add_f32 v40, v40, v41
  v_add_f32 v42, v42, v43
  v_add_f32 v40, v40, v42
  v_cvt_pk_bf16_f32 v40, v40, v40
  v_and_b32 v40, 0xffff0000, v40
  v_mul_f32 v36, v36, v40
  v_cmp_gt_u32 vcc, 1376, v123
  s_nop 1
  v_cndmask_b32 v36, 0, v36, vcc
  v_cvt_pk_bf16_f32 v8, v36, v36
  s_nop 1
  v_and_b32_dpp v10, v8, v4 row_newbcast:0 row_mask:0xf bank_mask:0xf
  v_and_b32_dpp v11, v8, v5 row_newbcast:0 row_mask:0xf bank_mask:0xf
  v_and_b32_dpp v12, v8, v6 row_newbcast:0 row_mask:0xf bank_mask:0xf
  v_and_b32_dpp v13, v8, v7 row_newbcast:0 row_mask:0xf bank_mask:0xf
  v_and_b32_dpp v14, v8, v4 row_newbcast:1 row_mask:0xf bank_mask:0xf
  v_and_b32_dpp v15, v8, v5 row_newbcast:1 row_mask:0xf bank_mask:0xf
  v_and_b32_dpp v16, v8, v6 row_newbcast:1 row_mask:0xf bank_mask:0xf
  v_and_b32_dpp v17, v8, v7 row_newbcast:1 row_mask:0xf bank_mask:0xf
  v_mfma_f32_16x16x32_bf16 v[18:21], v[10:13], v[48:51], 0
  v_mfma_f32_16x16x32_bf16 v[22:25], v[10:13], v[52:55], 0
  v_mfma_f32_16x16x32_bf16 v[26:29], v[10:13], v[56:59], 0
  v_mfma_f32_16x16x32_bf16 v[30:33], v[10:13], v[60:63], 0
  v_and_b32_dpp v10, v8, v4 row_newbcast:2 row_mask:0xf bank_mask:0xf
  v_and_b32_dpp v11, v8, v5 row_newbcast:2 row_mask:0xf bank_mask:0xf
  v_and_b32_dpp v12, v8, v6 row_newbcast:2 row_mask:0xf bank_mask:0xf
  v_and_b32_dpp v13, v8, v7 row_newbcast:2 row_mask:0xf bank_mask:0xf
  v_mfma_f32_16x16x32_bf16 v[18:21], v[14:17], v[64:67], v[18:21]
  v_mfma_f32_16x16x32_bf16 v[22:25], v[14:17], v[68:71], v[22:25]
  v_mfma_f32_16x16x32_bf16 v[26:29], v[14:17], v[72:75], v[26:29]
  v_mfma_f32_16x16x32_bf16 v[30:33], v[14:17], v[76:79], v[30:33]
  v_and_b32_dpp v14, v8, v4 row_newbcast:3 row_mask:0xf bank_mask:0xf
  v_and_b32_dpp v15, v8, v5 row_newbcast:3 row_mask:0xf bank_mask:0xf
  v_and_b32_dpp v16, v8, v6 row_newbcast:3 row_mask:0xf bank_mask:0xf
  v_and_b32_dpp v17, v8, v7 row_newbcast:3 row_mask:0xf bank_mask:0xf
  v_mfma_f32_16x16x32_bf16 v[18:21], v[10:13], v[80:83], v[18:21]
  v_mfma_f32_16x16x32_bf16 v[22:25], v[10:13], v[84:87], v[22:25]
  v_mfma_f32_16x16x32_bf16 v[26:29], v[10:13], v[88:91], v[26:29]
  v_mfma_f32_16x16x32_bf16 v[30:33], v[10:13], v[92:95], v[30:33]
  s_nop 0
  v_mfma_f32_16x16x32_bf16 v[18:21], v[14:17], v[96:99], v[18:21]
  v_mfma_f32_16x16x32_bf16 v[22:25], v[14:17], v[100:103], v[22:25]
  v_mfma_f32_16x16x32_bf16 v[26:29], v[14:17], v[104:107], v[26:29]
  v_mfma_f32_16x16x32_bf16 v[30:33], v[14:17], v[108:111], v[30:33]
  s_nop 7
  s_lshl_b32 s70, s3, 11
  s_add_u32 s70, s70, 4096
  v_add_u32 v34, s70, v116
  s_mov_b32 exec_hi, 0
  ds_write_b128 v34, v[18:21] offset:0
  ds_write_b128 v34, v[22:25] offset:512
  ds_write_b128 v34, v[26:29] offset:1024
  ds_write_b128 v34, v[30:33] offset:1536
  s_mov_b32 exec_hi, -1
  s_waitcnt lgkmcnt(0)
  s_barrier
  v_add_u32 v34, 4096, v118
  ds_read_b128 v[48:51], v34 offset:0
  ds_read_b128 v[52:55], v34 offset:2048
  ds_read_b128 v[56:59], v34 offset:4096
  ds_read_b128 v[60:63], v34 offset:6144
  s_waitcnt lgkmcnt(0)
  v_add_f32 v38, v48, v52
  v_add_f32 v35, v56, v60
  v_add_f32 v38, v38, v35
  v_add_f32 v39, v49, v53
  v_add_f32 v35, v57, v61
  v_add_f32 v39, v39, v35
  v_add_f32 v40, v50, v54
  v_add_f32 v35, v58, v62
  v_add_f32 v40, v40, v35
  v_add_f32 v41, v51, v55
  v_add_f32 v35, v59, v63
  v_add_f32 v41, v41, v35
  s_mul_i32 s70, s68, 45056
  s_lshl_b32 s71, s2, 11
  s_add_u32 s70, s70, s71
  s_add_u32 s70, s70, 303104
  s_mov_b32 exec_hi, 0
  buffer_store_dwordx4 v[38:41], v118, s[36:39], s70 offen sc0 sc1
  s_mov_b32 exec_hi, -1
  s_setpc_b64 s[64:65]
L_stageF1:
  s_mul_i32 s72, s68, 45056
  s_add_u32 s72, s72, 303104
  s_mov_b32 s98, 0
L_fpoll_46:
  s_mov_b32 s70, s72
  buffer_load_dwordx4 v[48:51], v117, s[36:39], s70 offen sc1
  s_add_u32 s70, s70, 4096
  buffer_load_dwordx4 v[52:55], v117, s[36:39], s70 offen sc1
  s_add_u32 s70, s70, 4096
  buffer_load_dwordx4 v[56:59], v117, s[36:39], s70 offen sc1
  s_add_u32 s70, s70, 4096
  buffer_load_dwordx4 v[60:63], v117, s[36:39], s70 offen sc1
  s_add_u32 s70, s70, 4096
  buffer_load_dwordx4 v[64:67], v117, s[36:39], s70 offen sc1
  s_add_u32 s70, s70, 4096
  buffer_load_dwordx4 v[68:71], v117, s[36:39], s70 offen sc1
  s_add_u32 s70, s70, 4096
  buffer_load_dwordx4 v[72:75], v117, s[36:39], s70 offen sc1
  s_add_u32 s70, s70, 4096
  buffer_load_dwordx4 v[76:79], v117, s[36:39], s70 offen sc1
  s_add_u32 s70, s70, 4096
  buffer_load_dwordx4 v[80:83], v117, s[36:39], s70 offen sc1
  s_add_u32 s70, s70, 4096
  buffer_load_dwordx4 v[84:87], v117, s[36:39], s70 offen sc1
  s_add_u32 s70, s70, 4096
  buffer_load_dwordx4 v[88:91], v117, s[36:39], s70 offen sc1
  s_waitcnt vmcnt(0)
  v_max_u32 v34, v48, v49
  v_max3_u32 v34, v34, v50, v51
  v_max3_u32 v34, v34, v52, v53
  v_max3_u32 v34, v34, v54, v55
  v_max3_u32 v34, v34, v56, v57
  v_max3_u32 v34, v34, v58, v59
  v_max3_u32 v34, v34, v60, v61
  v_max3_u32 v34, v34, v62, v63
  v_max3_u32 v34, v34, v64, v65
  v_max3_u32 v34, v34, v66, v67
  v_max3_u32 v34, v34, v68, v69
  v_max3_u32 v34, v34, v70, v71
  v_max3_u32 v34, v34, v72, v73
  v_max3_u32 v34, v34, v74, v75
  v_max3_u32 v34, v34, v76, v77
  v_max3_u32 v34, v34, v78, v79
  v_max3_u32 v34, v34, v80, v81
  v_max3_u32 v34, v34, v82, v83
  v_max3_u32 v34, v34, v84, v85
  v_max3_u32 v34, v34, v86, v87
  v_max3_u32 v34, v34, v88, v89
  v_max3_u32 v34, v34, v90, v91
  v_cmp_eq_u32 vcc, -1, v34
  s_nop 4
  s_cbranch_vccz L_fpolld_47
  s_add_u32 s98, s98, 1
  s_cmp_gt_u32 s98, 400000
  s_cbranch_scc1 L_fpolld_47_to
  s_cmp_lg_u32 s99, 0
  s_cbranch_scc1 L_fpolld_47
  s_branch L_fpoll_46
L_fpolld_47_to:
  s_mov_b32 s99, 1
L_fpolld_47:
  v_add_u32 v34, s69, v118
  ds_read_b128 v[42:45], v34
  v_add_f32 v38, v48, v52
  v_add_f32 v39, v49, v53
  v_add_f32 v40, v50, v54
  v_add_f32 v41, v51, v55
  v_add_f32 v38, v38, v56
  v_add_f32 v39, v39, v57
  v_add_f32 v40, v40, v58
  v_add_f32 v41, v41, v59
  v_add_f32 v38, v38, v60
  v_add_f32 v39, v39, v61
  v_add_f32 v40, v40, v62
  v_add_f32 v41, v41, v63
  v_add_f32 v38, v38, v64
  v_add_f32 v39, v39, v65
  v_add_f32 v40, v40, v66
  v_add_f32 v41, v41, v67
  v_add_f32 v38, v38, v68
  v_add_f32 v39, v39, v69
  v_add_f32 v40, v40, v70
  v_add_f32 v41, v41, v71
  v_add_f32 v38, v38, v72
  v_add_f32 v39, v39, v73
  v_add_f32 v40, v40, v74
  v_add_f32 v41, v41, v75
  v_add_f32 v38, v38, v76
  v_add_f32 v39, v39, v77
  v_add_f32 v40, v40, v78
  v_add_f32 v41, v41, v79
  v_add_f32 v38, v38, v80
  v_add_f32 v39, v39, v81
  v_add_f32 v40, v40, v82
  v_add_f32 v41, v41, v83
  v_add_f32 v38, v38, v84
  v_add_f32 v39, v39, v85
  v_add_f32 v40, v40, v86
  v_add_f32 v41, v41, v87
  v_add_f32 v38, v38, v88
  v_add_f32 v39, v39, v89
  v_add_f32 v40, v40, v90
  v_add_f32 v41, v41, v91
  v_mov_b32 v10, v38
  v_mov_b32 v11, v39
  v_mov_b32 v12, v40
  v_mov_b32 v13, v41
  s_nop 1
  v_permlane32_swap_b32 v38, v10
  v_permlane32_swap_b32 v39, v11
  v_permlane32_swap_b32 v40, v12
  v_permlane32_swap_b32 v41, v13
  s_nop 1
  v_add_f32 v38, v38, v10
  v_cvt_pk_bf16_f32 v38, v38, v38
  v_and_b32 v38, 0xffff0000, v38
  v_add_f32 v39, v39, v11
  v_cvt_pk_bf16_f32 v39, v39, v39
  v_and_b32 v39, 0xffff0000, v39
  v_add_f32 v40, v40, v12
  v_cvt_pk_bf16_f32 v40, v40, v40
  v_and_b32 v40, 0xffff0000, v40
  v_add_f32 v41, v41, v13
  v_cvt_pk_bf16_f32 v41, v41, v41
  v_and_b32 v41, 0xffff0000, v41
  s_waitcnt lgkmcnt(0)
  v_add_f32 v38, v38, v42
  v_cvt_pk_bf16_f32 v38, v38, v38
  v_and_b32 v38, 0xffff0000, v38
  v_add_f32 v39, v39, v43
  v_cvt_pk_bf16_f32 v39, v39, v39
  v_and_b32 v39, 0xffff0000, v39
  v_add_f32 v40, v40, v44
  v_cvt_pk_bf16_f32 v40, v40, v40
  v_and_b32 v40, 0xffff0000, v40
  v_add_f32 v41, v41, v45
  v_cvt_pk_bf16_f32 v41, v41, v41
  v_and_b32 v41, 0xffff0000, v41
  ds_write_b128 v34, v[38:41]
  s_waitcnt lgkmcnt(0)
  s_barrier
  s_setpc_b64 s[64:65]
L_chain_main:
  v_lshlrev_b32 v38, 16, v42
  v_and_b32 v39, 0xffff0000, v42
  v_lshlrev_b32 v40, 16, v43
  v_and_b32 v41, 0xffff0000, v43
  v_add_u32 v35, 0, v117
  ds_write_b128 v35, v[38:41]
  s_waitcnt lgkmcnt(0)
  s_barrier
  v_mov_b32 v42, 0
  s_mov_b32 s98, 0
L_winit_48:
  buffer_load_dword v43, v42, s[40:43], 0 offen sc1
  s_waitcnt vmcnt(0)
  v_readfirstlane_b32 s97, v43
  s_cmp_ge_u32 s97, 32
  s_cbranch_scc1 L_winit_done_49
  s_add_u32 s98, s98, 1
  s_cmp_gt_u32 s98, 400000
  s_cbranch_scc1 L_winit_done_49_to
  s_cmp_lg_u32 s99, 0
  s_cbranch_scc1 L_winit_done_49
  s_sleep 2
  s_branch L_winit_48
L_winit_done_49_to:
  s_mov_b32 s99, 1
L_winit_done_49:
  s_mov_b32 s68, 0
  s_mov_b32 s69, 2048
  s_call_b64 s[64:65], L_qproj
  s_mov_b32 s68, 1
  s_mov_b32 s69, 0
  s_call_b64 s[64:65], L_qproj
  s_lshl_b32 s70, s3, 5
  s_add_u32 s70, s70, s2
  s_mul_i32 s70, s70, 17920
  s_add_u32 s70, s70, 589824
  v_mov_b32 v48, -1
  v_mov_b32 v49, -1
  v_mov_b32 v50, -1
  v_mov_b32 v51, -1
  v_lshlrev_b32 v40, 4, v0
  buffer_store_dwordx4 v[48:51], v40, s[36:39], s70 offen sc0 sc1
  s_add_u32 s70, s70, 1024
  buffer_store_dwordx4 v[48:51], v40, s[36:39], s70 offen sc0 sc1
  s_add_u32 s70, s70, 1024
  buffer_store_dwordx4 v[48:51], v40, s[36:39], s70 offen sc0 sc1
  s_add_u32 s70, s70, 1024
  buffer_store_dwordx4 v[48:51], v40, s[36:39], s70 offen sc0 sc1
  s_add_u32 s70, s70, 1024
  buffer_store_dwordx4 v[48:51], v40, s[36:39], s70 offen sc0 sc1
  s_add_u32 s70, s70, 1024
  buffer_store_dwordx4 v[48:51], v40, s[36:39], s70 offen sc0 sc1
  s_add_u32 s70, s70, 1024
  buffer_store_dwordx4 v[48:51], v40, s[36:39], s70 offen sc0 sc1
  s_add_u32 s70, s70, 1024
  buffer_store_dwordx4 v[48:51], v40, s[36:39], s70 offen sc0 sc1
  s_add_u32 s70, s70, 1024
  buffer_store_dwordx4 v[48:51], v40, s[36:39], s70 offen sc0 sc1
  s_add_u32 s70, s70, 1024
  buffer_store_dwordx4 v[48:51], v40, s[36:39], s70 offen sc0 sc1
  s_add_u32 s70, s70, 1024
  buffer_store_dwordx4 v[48:51], v40, s[36:39], s70 offen sc0 sc1
  s_add_u32 s70, s70, 1024
  buffer_store_dwordx4 v[48:51], v40, s[36:39], s70 offen sc0 sc1
  s_add_u32 s70, s70, 1024
  buffer_store_dwordx4 v[48:51], v40, s[36:39], s70 offen sc0 sc1
  s_add_u32 s70, s70, 1024
  buffer_store_dwordx4 v[48:51], v40, s[36:39], s70 offen sc0 sc1
  s_add_u32 s70, s70, 1024
  buffer_store_dwordx4 v[48:51], v40, s[36:39], s70 offen sc0 sc1
  s_add_u32 s70, s70, 1024
  buffer_store_dwordx4 v[48:51], v40, s[36:39], s70 offen sc0 sc1
  s_add_u32 s70, s70, 1024
  buffer_store_dwordx4 v[48:51], v40, s[36:39], s70 offen sc0 sc1
  s_add_u32 s70, s70, 1024
  s_mov_b32 exec_hi, 0
  buffer_store_dwordx4 v[48:51], v40, s[36:39], s70 offen sc0 sc1
  s_mov_b32 exec_hi, -1
  s_waitcnt vmcnt(0)
  s_barrier
  s_cmp_lg_u32 s3, 0
  s_cbranch_scc1 L_nosig2_50
  v_mov_b32 v42, 1
  v_mov_b32 v43, 4
  s_mov_b64 exec, 1
  buffer_atomic_add v42, v43, s[40:43], 0 offen sc1
  s_mov_b64 exec, -1
L_nosig2_50:
  s_lshl_b32 s70, s2, 17
  s_lshl_b32 s71, s3, 15
  s_add_u32 s70, s70, s71
  buffer_load_dwordx4 a[0:3], v1, s[44:47], s70 offen offset:0 nt
  buffer_load_dwordx4 a[4:7], v1, s[44:47], s70 offen offset:256 nt
  buffer_load_dwordx4 a[8:11], v1, s[44:47], s70 offen offset:512 nt
  buffer_load_dwordx4 a[12:15], v1, s[44:47], s70 offen offset:768 nt
  s_add_u32 s70, s70, 4096
  buffer_load_dwordx4 a[16:19], v1, s[44:47], s70 offen offset:0 nt
  buffer_load_dwordx4 a[20:23], v1, s[44:47], s70 offen offset:256 nt
  buffer_load_dwordx4 a[24:27], v1, s[44:47], s70 offen offset:512 nt
  buffer_load_dwordx4 a[28:31], v1, s[44:47], s70 offen offset:768 nt
  s_add_u32 s70, s70, 4096
  buffer_load_dwordx4 a[32:35], v1, s[44:47], s70 offen offset:0 nt
  buffer_load_dwordx4 a[36:39], v1, s[44:47], s70 offen offset:256 nt
  buffer_load_dwordx4 a[40:43], v1, s[44:47], s70 offen offset:512 nt
  buffer_load_dwordx4 a[44:47], v1, s[44:47], s70 offen offset:768 nt
  s_add_u32 s70, s70, 4096
  buffer_load_dwordx4 a[48:51], v1, s[44:47], s70 offen offset:0 nt
  buffer_load_dwordx4 a[52:55], v1, s[44:47], s70 offen offset:256 nt
  buffer_load_dwordx4 a[56:59], v1, s[44:47], s70 offen offset:512 nt
  buffer_load_dwordx4 a[60:63], v1, s[44:47], s70 offen offset:768 nt
  s_add_u32 s70, s70, 4096
  buffer_load_dwordx4 a[64:67], v1, s[44:47], s70 offen offset:0 nt
  buffer_load_dwordx4 a[68:71], v1, s[44:47], s70 offen offset:256 nt
  buffer_load_dwordx4 a[72:75], v1, s[44:47], s70 offen offset:512 nt
  buffer_load_dwordx4 a[76:79], v1, s[44:47], s70 offen offset:768 nt
  s_add_u32 s70, s70, 4096
  buffer_load_dwordx4 a[80:83], v1, s[44:47], s70 offen offset:0 nt
  buffer_load_dwordx4 a[84:87], v1, s[44:47], s70 offen offset:256 nt
  buffer_load_dwordx4 a[88:91], v1, s[44:47], s70 offen offset:512 nt
  buffer_load_dwordx4 a[92:95], v1, s[44:47], s70 offen offset:768 nt
  s_add_u32 s70, s70, 4096
  buffer_load_dwordx4 a[96:99], v1, s[44:47], s70 offen offset:0 nt
  buffer_load_dwordx4 a[100:103], v1, s[44:47], s70 offen offset:256 nt
  buffer_load_dwordx4 a[104:107], v1, s[44:47], s70 offen offset:512 nt
  buffer_load_dwordx4 a[108:111], v1, s[44:47], s70 offen offset:768 nt
  s_add_u32 s70, s70, 4096
  buffer_load_dwordx4 a[112:115], v1, s[44:47], s70 offen offset:0 nt
  buffer_load_dwordx4 a[116:119], v1, s[44:47], s70 offen offset:256 nt
  buffer_load_dwordx4 a[120:123], v1, s[44:47], s70 offen offset:512 nt
  buffer_load_dwordx4 a[124:127], v1, s[44:47], s70 offen offset:768 nt
  s_add_u32 s70, s70, 4096
  s_cmp_ge_u32 s2, 22
  s_cbranch_scc1 L_noffnw_51
  s_mul_i32 s70, s3, 352256
  s_lshl_b32 s71, s2, 7
  s_add_u32 s70, s70, s71
  s_mov_b32 exec_lo, 0x00ff00ff
  s_mov_b32 exec_hi, 0x00ff00ff
  buffer_load_dwordx4 v[128:131], v3, s[48:51], s70 offen nt
  s_mov_b32 exec_lo, 0xff00ff00
  s_mov_b32 exec_hi, 0xff00ff00
  buffer_load_dwordx4 v[128:131], v3, s[52:55], s70 offen nt
  s_add_u32 s70, s70, 11008
  s_mov_b32 exec_lo, 0x00ff00ff
  s_mov_b32 exec_hi, 0x00ff00ff
  buffer_load_dwordx4 v[132:135], v3, s[48:51], s70 offen nt
  s_mov_b32 exec_lo, 0xff00ff00
  s_mov_b32 exec_hi, 0xff00ff00
  buffer_load_dwordx4 v[132:135], v3, s[52:55], s70 offen nt
  s_add_u32 s70, s70, 11008
  s_mov_b32 exec_lo, 0x00ff00ff
  s_mov_b32 exec_hi, 0x00ff00ff
  buffer_load_dwordx4 v[136:139], v3, s[48:51], s70 offen nt
  s_mov_b32 exec_lo, 0xff00ff00
  s_mov_b32 exec_hi, 0xff00ff00
  buffer_load_dwordx4 v[136:139], v3, s[52:55], s70 offen nt
  s_add_u32 s70, s70, 11008
  s_mov_b32 exec_lo, 0x00ff00ff
  s_mov_b32 exec_hi, 0x00ff00ff
  buffer_load_dwordx4 v[140:143], v3, s[48:51], s70 offen nt
  s_mov_b32 exec_lo, 0xff00ff00
  s_mov_b32 exec_hi, 0xff00ff00
  buffer_load_dwordx4 v[140:143], v3, s[52:55], s70 offen nt
  s_add_u32 s70, s70, 11008
  s_mov_b32 exec_lo, 0x00ff00ff
  s_mov_b32 exec_hi, 0x00ff00ff
  buffer_load_dwordx4 v[144:147], v3, s[48:51], s70 offen nt
  s_mov_b32 exec_lo, 0xff00ff00
  s_mov_b32 exec_hi, 0xff00ff00
  buffer_load_dwordx4 v[144:147], v3, s[52:55], s70 offen nt
  s_add_u32 s70, s70, 11008
  s_mov_b32 exec_lo, 0x00ff00ff
  s_mov_b32 exec_hi, 0x00ff00ff
  buffer_load_dwordx4 v[148:151], v3, s[48:51], s70 offen nt
  s_mov_b32 exec_lo, 0xff00ff00
  s_mov_b32 exec_hi, 0xff00ff00
  buffer_load_dwordx4 v[148:151], v3, s[52:55], s70 offen nt
  s_add_u32 s70, s70, 11008
  s_mov_b32 exec_lo, 0x00ff00ff
  s_mov_b32 exec_hi, 0x00ff00ff
  buffer_load_dwordx4 v[152:155], v3, s[48:51], s70 offen nt
  s_mov_b32 exec_lo, 0xff00ff00
  s_mov_b32 exec_hi, 0xff00ff00
  buffer_load_dwordx4 v[152:155], v3, s[52:55], s70 offen nt
  s_add_u32 s70, s70, 11008
  s_mov_b32 exec_lo, 0x00ff00ff
  s_mov_b32 exec_hi, 0x00ff00ff
  buffer_load_dwordx4 v[156:159], v3, s[48:51], s70 offen nt
  s_mov_b32 exec_lo, 0xff00ff00
  s_mov_b32 exec_hi, 0xff00ff00
  buffer_load_dwordx4 v[156:159], v3, s[52:55], s70 offen nt
  s_add_u32 s70, s70, 11008
  s_mov_b32 exec_lo, 0x00ff00ff
  s_mov_b32 exec_hi, 0x00ff00ff
  buffer_load_dwordx4 v[160:163], v3, s[48:51], s70 offen nt
  s_mov_b32 exec_lo, 0xff00ff00
  s_mov_b32 exec_hi, 0xff00ff00
  buffer_load_dwordx4 v[160:163], v3, s[52:55], s70 offen nt
  s_add_u32 s70, s70, 11008
  s_mov_b32 exec_lo, 0x00ff00ff
  s_mov_b32 exec_hi, 0x00ff00ff
  buffer_load_dwordx4 v[164:167], v3, s[48:51], s70 offen nt
  s_mov_b32 exec_lo, 0xff00ff00
  s_mov_b32 exec_hi, 0xff00ff00
  buffer_load_dwordx4 v[164:167], v3, s[52:55], s70 offen nt
  s_add_u32 s70, s70, 11008
  s_mov_b32 exec_lo, 0x00ff00ff
  s_mov_b32 exec_hi, 0x00ff00ff
  buffer_load_dwordx4 v[168:171], v3, s[48:51], s70 offen nt
  s_mov_b32 exec_lo, 0xff00ff00
  s_mov_b32 exec_hi, 0xff00ff00
  buffer_load_dwordx4 v[168:171], v3, s[52:55], s70 offen nt
  s_add_u32 s70, s70, 11008
  s_mov_b32 exec_lo, 0x00ff00ff
  s_mov_b32 exec_hi, 0x00ff00ff
  buffer_load_dwordx4 v[172:175], v3, s[48:51], s70 offen nt
  s_mov_b32 exec_lo, 0xff00ff00
  s_mov_b32 exec_hi, 0xff00ff00
  buffer_load_dwordx4 v[172:175], v3, s[52:55], s70 offen nt
  s_add_u32 s70, s70, 11008
  s_mov_b32 exec_lo, 0x00ff00ff
  s_mov_b32 exec_hi, 0x00ff00ff
  buffer_load_dwordx4 v[176:179], v3, s[48:51], s70 offen nt
  s_mov_b32 exec_lo, 0xff00ff00
  s_mov_b32 exec_hi, 0xff00ff00
  buffer_load_dwordx4 v[176:179], v3, s[52:55], s70 offen nt
  s_add_u32 s70, s70, 11008
  s_mov_b32 exec_lo, 0x00ff00ff
  s_mov_b32 exec_hi, 0x00ff00ff
  buffer_load_dwordx4 v[180:183], v3, s[48:51], s70 offen nt
  s_mov_b32 exec_lo, 0xff00ff00
  s_mov_b32 exec_hi, 0xff00ff00
  buffer_load_dwordx4 v[180:183], v3, s[52:55], s70 offen nt
  s_add_u32 s70, s70, 11008
  s_mov_b32 exec_lo, 0x00ff00ff
  s_mov_b32 exec_hi, 0x00ff00ff
  buffer_load_dwordx4 v[184:187], v3, s[48:51], s70 offen nt
  s_mov_b32 exec_lo, 0xff00ff00
  s_mov_b32 exec_hi, 0xff00ff00
  s_waitcnt vmcnt(40)
  buffer_load_dwordx4 v[184:187], v3, s[52:55], s70 offen nt
  s_add_u32 s70, s70, 11008
  s_mov_b32 exec_lo, 0x00ff00ff
  s_mov_b32 exec_hi, 0x00ff00ff
  buffer_load_dwordx4 v[188:191], v3, s[48:51], s70 offen nt
  s_mov_b32 exec_lo, 0xff00ff00
  s_mov_b32 exec_hi, 0xff00ff00
  buffer_load_dwordx4 v[188:191], v3, s[52:55], s70 offen nt
  s_add_u32 s70, s70, 11008
  s_mov_b32 exec_lo, 0x00ff00ff
  s_mov_b32 exec_hi, 0x00ff00ff
  buffer_load_dwordx4 v[192:195], v3, s[48:51], s70 offen nt
  s_mov_b32 exec_lo, 0xff00ff00
  s_mov_b32 exec_hi, 0xff00ff00
  buffer_load_dwordx4 v[192:195], v3, s[52:55], s70 offen nt
  s_add_u32 s70, s70, 11008
  s_mov_b32 exec_lo, 0x00ff00ff
  s_mov_b32 exec_hi, 0x00ff00ff
  buffer_load_dwordx4 v[196:199], v3, s[48:51], s70 offen nt
  s_mov_b32 exec_lo, 0xff00ff00
  s_mov_b32 exec_hi, 0xff00ff00
  buffer_load_dwordx4 v[196:199], v3, s[52:55], s70 offen nt
  s_add_u32 s70, s70, 11008
  s_mov_b32 exec_lo, 0x00ff00ff
  s_mov_b32 exec_hi, 0x00ff00ff
  buffer_load_dwordx4 v[200:203], v3, s[48:51], s70 offen nt
  s_mov_b32 exec_lo, 0xff00ff00
  s_mov_b32 exec_hi, 0xff00ff00
  buffer_load_dwordx4 v[200:203], v3, s[52:55], s70 offen nt
  s_add_u32 s70, s70, 11008
  s_mov_b32 exec_lo, 0x00ff00ff
  s_mov_b32 exec_hi, 0x00ff00ff
  buffer_load_dwordx4 v[204:207], v3, s[48:51], s70 offen nt
  s_mov_b32 exec_lo, 0xff00ff00
  s_mov_b32 exec_hi, 0xff00ff00
  buffer_load_dwordx4 v[204:207], v3, s[52:55], s70 offen nt
  s_add_u32 s70, s70, 11008
  s_mov_b32 exec_lo, 0x00ff00ff
  s_mov_b32 exec_hi, 0x00ff00ff
  buffer_load_dwordx4 v[208:211], v3, s[48:51], s70 offen nt
  s_mov_b32 exec_lo, 0xff00ff00
  s_mov_b32 exec_hi, 0xff00ff00
  buffer_load_dwordx4 v[208:211], v3, s[52:55], s70 offen nt
  s_add_u32 s70, s70, 11008
  s_mov_b32 exec_lo, 0x00ff00ff
  s_mov_b32 exec_hi, 0x00ff00ff
  buffer_load_dwordx4 v[212:215], v3, s[48:51], s70 offen nt
  s_mov_b32 exec_lo, 0xff00ff00
  s_mov_b32 exec_hi, 0xff00ff00
  buffer_load_dwordx4 v[212:215], v3, s[52:55], s70 offen nt
  s_add_u32 s70, s70, 11008
  s_mov_b32 exec_lo, 0x00ff00ff
  s_mov_b32 exec_hi, 0x00ff00ff
  buffer_load_dwordx4 v[216:219], v3, s[48:51], s70 offen nt
  s_mov_b32 exec_lo, 0xff00ff00
  s_mov_b32 exec_hi, 0xff00ff00
  buffer_load_dwordx4 v[216:219], v3, s[52:55], s70 offen nt
  s_add_u32 s70, s70, 11008
  s_mov_b32 exec_lo, 0x00ff00ff
  s_mov_b32 exec_hi, 0x00ff00ff
  buffer_load_dwordx4 v[220:223], v3, s[48:51], s70 offen nt
  s_mov_b32 exec_lo, 0xff00ff00
  s_mov_b32 exec_hi, 0xff00ff00
  buffer_load_dwordx4 v[220:223], v3, s[52:55], s70 offen nt
  s_add_u32 s70, s70, 11008
  s_mov_b32 exec_lo, 0x00ff00ff
  s_mov_b32 exec_hi, 0x00ff00ff
  buffer_load_dwordx4 v[224:227], v3, s[48:51], s70 offen nt
  s_mov_b32 exec_lo, 0xff00ff00
  s_mov_b32 exec_hi, 0xff00ff00
  buffer_load_dwordx4 v[224:227], v3, s[52:55], s70 offen nt
  s_add_u32 s70, s70, 11008
  s_mov_b32 exec_lo, 0x00ff00ff
  s_mov_b32 exec_hi, 0x00ff00ff
  buffer_load_dwordx4 v[228:231], v3, s[48:51], s70 offen nt
  s_mov_b32 exec_lo, 0xff00ff00
  s_mov_b32 exec_hi, 0xff00ff00
  s_waitcnt vmcnt(40)
  buffer_load_dwordx4 v[228:231], v3, s[52:55], s70 offen nt
  s_add_u32 s70, s70, 11008
  s_mov_b32 exec_lo, 0x00ff00ff
  s_mov_b32 exec_hi, 0x00ff00ff
  buffer_load_dwordx4 v[232:235], v3, s[48:51], s70 offen nt
  s_mov_b32 exec_lo, 0xff00ff00
  s_mov_b32 exec_hi, 0xff00ff00
  buffer_load_dwordx4 v[232:235], v3, s[52:55], s70 offen nt
  s_add_u32 s70, s70, 11008
  s_mov_b32 exec_lo, 0x00ff00ff
  s_mov_b32 exec_hi, 0x00ff00ff
  buffer_load_dwordx4 v[236:239], v3, s[48:51], s70 offen nt
  s_mov_b32 exec_lo, 0xff00ff00
  s_mov_b32 exec_hi, 0xff00ff00
  buffer_load_dwordx4 v[236:239], v3, s[52:55], s70 offen nt
  s_add_u32 s70, s70, 11008
  s_mov_b32 exec_lo, 0x00ff00ff
  s_mov_b32 exec_hi, 0x00ff00ff
  buffer_load_dwordx4 v[240:243], v3, s[48:51], s70 offen nt
  s_mov_b32 exec_lo, 0xff00ff00
  s_mov_b32 exec_hi, 0xff00ff00
  buffer_load_dwordx4 v[240:243], v3, s[52:55], s70 offen nt
  s_add_u32 s70, s70, 11008
  s_mov_b32 exec_lo, 0x00ff00ff
  s_mov_b32 exec_hi, 0x00ff00ff
  buffer_load_dwordx4 v[244:247], v3, s[48:51], s70 offen nt
  s_mov_b32 exec_lo, 0xff00ff00
  s_mov_b32 exec_hi, 0xff00ff00
  buffer_load_dwordx4 v[244:247], v3, s[52:55], s70 offen nt
  s_add_u32 s70, s70, 11008
  s_mov_b32 exec_lo, 0x00ff00ff
  s_mov_b32 exec_hi, 0x00ff00ff
  buffer_load_dwordx4 v[248:251], v3, s[48:51], s70 offen nt
  s_mov_b32 exec_lo, 0xff00ff00
  s_mov_b32 exec_hi, 0xff00ff00
  buffer_load_dwordx4 v[248:251], v3, s[52:55], s70 offen nt
  s_add_u32 s70, s70, 11008
  s_mov_b32 exec_lo, 0x00ff00ff
  s_mov_b32 exec_hi, 0x00ff00ff
  buffer_load_dwordx4 v[252:255], v3, s[48:51], s70 offen nt
  s_mov_b32 exec_lo, 0xff00ff00
  s_mov_b32 exec_hi, 0xff00ff00
  buffer_load_dwordx4 v[252:255], v3, s[52:55], s70 offen nt
  s_add_u32 s70, s70, 11008
  s_mov_b64 exec, -1
  s_lshl_b32 s70, s2, 16
  s_lshl_b32 s71, s3, 14
  s_add_u32 s70, s70, s71
  s_lshl_b32 s71, s3, 14
  s_add_u32 s71, s71, 16384
  s_add_u32 m0, s71, 0
  s_add_u32 s72, s70, 0
  buffer_load_dwordx4 v1, s[56:59], s72 offen nt lds
  s_add_u32 m0, s71, 1024
  s_add_u32 s72, s70, 256
  buffer_load_dwordx4 v1, s[56:59], s72 offen nt lds
  s_add_u32 m0, s71, 2048
  s_add_u32 s72, s70, 512
  buffer_load_dwordx4 v1, s[56:59], s72 offen nt lds
  s_add_u32 m0, s71, 3072
  s_add_u32 s72, s70, 768
  buffer_load_dwordx4 v1, s[56:59], s72 offen nt lds
  s_add_u32 m0, s71, 4096
  s_add_u32 s72, s70, 4096
  buffer_load_dwordx4 v1, s[56:59], s72 offen nt lds
  s_add_u32 m0, s71, 5120
  s_add_u32 s72, s70, 4352
  buffer_load_dwordx4 v1, s[56:59], s72 offen nt lds
  s_add_u32 m0, s71, 6144
  s_add_u32 s72, s70, 4608
  buffer_load_dwordx4 v1, s[56:59], s72 offen nt lds
  s_add_u32 m0, s71, 7168
  s_add_u32 s72, s70, 4864
  buffer_load_dwordx4 v1, s[56:59], s72 offen nt lds
  s_add_u32 m0, s71, 8192
  s_add_u32 s72, s70, 8192
  buffer_load_dwordx4 v1, s[56:59], s72 offen nt lds
  s_add_u32 m0, s71, 9216
  s_add_u32 s72, s70, 8448
  s_waitcnt vmcnt(40)
  buffer_load_dwordx4 v1, s[56:59], s72 offen nt lds
  s_add_u32 m0, s71, 10240
  s_add_u32 s72, s70, 8704
  buffer_load_dwordx4 v1, s[56:59], s72 offen nt lds
  s_add_u32 m0, s71, 11264
  s_add_u32 s72, s70, 8960
  buffer_load_dwordx4 v1, s[56:59], s72 offen nt lds
  s_add_u32 m0, s71, 12288
  s_add_u32 s72, s70, 12288
  buffer_load_dwordx4 v1, s[56:59], s72 offen nt lds
  s_add_u32 m0, s71, 13312
  s_add_u32 s72, s70, 12544
  buffer_load_dwordx4 v1, s[56:59], s72 offen nt lds
  s_add_u32 m0, s71, 14336
  s_add_u32 s72, s70, 12800
  buffer_load_dwordx4 v1, s[56:59], s72 offen nt lds
  s_add_u32 m0, s71, 15360
  s_add_u32 s72, s70, 13056
  buffer_load_dwordx4 v1, s[56:59], s72 offen nt lds
L_noffnw_51:
  v_mov_b32 v42, 4
  s_mov_b32 s98, 0
L_winit_52:
  buffer_load_dword v43, v42, s[40:43], 0 offen sc1
  s_waitcnt vmcnt(0)
  v_readfirstlane_b32 s97, v43
  s_cmp_ge_u32 s97, 32
  s_cbranch_scc1 L_winit_done_53
  s_add_u32 s98, s98, 1
  s_cmp_gt_u32 s98, 400000
  s_cbranch_scc1 L_winit_done_53_to
  s_cmp_lg_u32 s99, 0
  s_cbranch_scc1 L_winit_done_53
  s_sleep 2
  s_branch L_winit_52
L_winit_done_53_to:
  s_mov_b32 s99, 1
L_winit_done_53:
  s_mov_b32 s68, 0
  s_mov_b32 s69, 2048
  s_call_b64 s[64:65], L_stageB
  s_call_b64 s[64:65], L_stageD1
  s_cmp_ge_u32 s2, 22
  s_cbranch_scc1 L_nonffn_54
  s_call_b64 s[64:65], L_stageD2
L_nonffn_54:
  s_call_b64 s[64:65], L_stageF1
  s_mov_b32 s68, 2
  s_call_b64 s[64:65], L_qproj
  s_mov_b32 s68, 1
  s_mov_b32 s69, 0
  s_call_b64 s[64:65], L_stageB
  s_call_b64 s[64:65], L_stageD1
  s_cmp_ge_u32 s2, 22
  s_cbranch_scc1 L_nonffn_55
  s_call_b64 s[64:65], L_stageD2
L_nonffn_55:
  s_call_b64 s[64:65], L_stageF1
  s_mov_b32 s68, 3
  s_call_b64 s[64:65], L_qproj
  s_mov_b32 s68, 2
  s_mov_b32 s69, 2048
  s_call_b64 s[64:65], L_stageB
  s_cmp_ge_u32 s2, 22
  s_cbranch_scc1 L_nonffn_56
  s_call_b64 s[64:65], L_stageD1
  s_call_b64 s[64:65], L_stageD2
L_nonffn_56:
  s_cmp_lg_u32 s2, 0
  s_cbranch_scc1 L_noout_57
  s_call_b64 s[64:65], L_stageF1
  v_cvt_pk_bf16_f32 v42, v38, v39
  v_cvt_pk_bf16_f32 v43, v40, v41
  v_lshrrev_b32 v34, 1, v118
  s_mov_b32 s70, 1024
  s_mov_b32 exec_hi, 0
  buffer_store_dwordx2 v[42:43], v34, s[60:63], s70 offen
  s_mov_b32 exec_hi, -1
L_noout_57:
  s_barrier
  s_mov_b32 s68, 3
  s_mov_b32 s69, 0
  s_call_b64 s[64:65], L_stageB
  s_cmp_ge_u32 s2, 22
  s_cbranch_scc1 L_nonffn_58
  s_call_b64 s[64:65], L_stageD1
  s_call_b64 s[64:65], L_stageD2
L_nonffn_58:
  s_cmp_lg_u32 s2, 0
  s_cbranch_scc1 L_noout_59
  s_call_b64 s[64:65], L_stageF1
  v_cvt_pk_bf16_f32 v42, v38, v39
  v_cvt_pk_bf16_f32 v43, v40, v41
  v_lshrrev_b32 v34, 1, v118
  s_mov_b32 s70, 0
  s_mov_b32 exec_hi, 0
  buffer_store_dwordx2 v[42:43], v34, s[60:63], s70 offen
  s_mov_b32 exec_hi, -1
L_noout_59:
  s_barrier
  s_endpgm
L_end:
  s_endpgm

.section .rodata,"a"
.p2align 6
.amdhsa_kernel interleave_layers__gqa_block_cached__glu_gated_bilinear__decode_kernel
  .amdhsa_next_free_vgpr 512
  .amdhsa_next_free_sgpr 102
  .amdhsa_accum_offset 256
  .amdhsa_group_segment_fixed_size 0
  .amdhsa_kernarg_size 96
  .amdhsa_user_sgpr_count 2
  .amdhsa_user_sgpr_kernarg_segment_ptr 1
  .amdhsa_system_sgpr_workgroup_id_x 1
.end_amdhsa_kernel
```
